```python
import torch

def _softmax(x, axis=-1):
    return torch.softmax(x, dim=axis)
def _gelu(x):
    return torch.nn.functional.gelu(x, approximate="tanh")
def _silu(x):
    return torch.nn.functional.silu(x)
def _sigmoid(x):
    return torch.sigmoid(x)
def _layernorm(x, axis=-1, eps=1e-5):
    m = x.mean(dim=axis, keepdim=True)
    v = x.var(dim=axis, keepdim=True, unbiased=False)
    return (x - m) / torch.sqrt(v + eps)
def _scatter_add(tgt, idx, src, axis=0):
    return tgt.clone().index_add_(axis, idx, src)
def _segment_sum(src, seg, n):
    out = torch.zeros((n,) + src.shape[1:], dtype=src.dtype)
    return out.index_add_(0, seg, src)
def _pad(x, pw):
    flat = tuple(v for pair in reversed(pw) for v in pair)
    return torch.nn.functional.pad(x, flat)

kernel_name = 'interleave_layers__linear_kernel_hedgehog__sliding_local_dilated__prompt'

def setup_inputs():

    _w = (lambda a: (lambda t: t.to(torch.bfloat16) if t.is_floating_point() else t)(torch.as_tensor(a)))
    def _A_setup():
        B, S, D, H = 1, 2048, 512, 32
        Dh = D // H
        return {
            "x": _w((lambda *s: torch.randn(*s, dtype=torch.bfloat16) * 0.05)(B, S, D)),
            "wqkv": _w((lambda *s: torch.randn(*s, dtype=torch.bfloat16) * 0.4)(D, 3 * D)),
            "w_phi": _w((lambda *s: torch.randn(*s, dtype=torch.bfloat16) * 0.4)(H, Dh, Dh) * (Dh ** -0.5)),
            "wo": _w((lambda *s: torch.randn(*s, dtype=torch.bfloat16) * 0.05)(D, D)),
        }
    _A_in = _A_setup()

    def _B_setup():
        B, S, D = 1, 2048, 512
        return {
            "x": _w((lambda *s: torch.randn(*s, dtype=torch.bfloat16) * 0.05)(B, S, D)),
            "wqkv": _w((lambda *s: torch.randn(*s, dtype=torch.bfloat16) * 0.1)(D, 3 * D)),
            "wo": _w((lambda *s: torch.randn(*s, dtype=torch.bfloat16) * 0.05)(D, D)),
        }
    _B_in = _B_setup()

    return {
        "A_x": _A_in["x"],
        "A_wqkv": _A_in["wqkv"],
        "A_w_phi": _A_in["w_phi"],
        "A_wo": _A_in["wo"],
        "B_x": _B_in["x"],
        "B_wqkv": _B_in["wqkv"],
        "B_wo": _B_in["wo"],
    }

def reference(A_x, A_wqkv, A_w_phi, A_wo, B_x, B_wqkv, B_wo):
    def _A_ref(x, wqkv, w_phi, wo):
        B, S, D = x.shape
        H = 32; Dh = D // H
        qkv = (lambda x, *d: x.permute(*d))((x @ wqkv).reshape(B, S, 3, H, Dh), 2, 0, 3, 1, 4)
        q, k, v = qkv[0], qkv[1], qkv[2]
        pq = torch.einsum("bhsd,hdf->bhsf", q, w_phi)
        pk = torch.einsum("bhsd,hdf->bhsf", k, w_phi)
        phi_q = torch.concatenate([_softmax(pq, axis=-1), _softmax(-pq, axis=-1)], axis=-1)
        phi_k = torch.concatenate([_softmax(pk, axis=-1), _softmax(-pk, axis=-1)], axis=-1)
        kv = torch.einsum("bhsf,bhsd->bhfd", phi_k, v)
        z  = torch.einsum("bhsf->bhf", phi_k)
        num = torch.einsum("bhqf,bhfd->bhqd", phi_q, kv)
        den = torch.einsum("bhqf,bhf->bhq", phi_q, z)[..., None] + 1e-6
        o = num / den
        return (lambda x, *d: x.permute(*d))(o, 0, 2, 1, 3).reshape(B, S, D) @ wo

    def _B_ref(x, wqkv, wo):
        B, S, D = x.shape
        H = 32; Dh = D // H
        W, dil = 8, 2
        qkv = (lambda x, *d: x.permute(*d))((x @ wqkv).reshape(B, S, 3, H, Dh), 2, 0, 3, 1, 4)
        q, k, v = qkv[0], qkv[1], qkv[2]
        scale = Dh ** -0.5
        pos = torch.arange(S)
        off = torch.arange(W) * dil
        idx = pos[:, None] - off[None, :]
        mask = idx >= 0
        idx_c = torch.where(mask, idx, 0).reshape(-1)
        kg = k[:, :, idx_c, :].reshape(B, H, S, W, Dh)
        vg = v[:, :, idx_c, :].reshape(B, H, S, W, Dh)
        logits = torch.einsum("bhsd,bhswd->bhsw", q, kg) * scale
        logits = torch.where(mask[None, None, :, :], logits, -1e9)
        attn = _softmax(logits, axis=-1)
        o = torch.einsum("bhsw,bhswd->bhsd", attn, vg)
        return (lambda x, *d: x.permute(*d))(o, 0, 2, 1, 3).reshape(B, S, D) @ wo

    x = A_x
    x = x + _A_ref(_layernorm(x, axis=-1), A_wqkv, A_w_phi, A_wo)
    x = x + _B_ref(_layernorm(x, axis=-1), B_wqkv, B_wo)
    x = x + _A_ref(_layernorm(x, axis=-1), A_wqkv, A_w_phi, A_wo)
    x = x + _B_ref(_layernorm(x, axis=-1), B_wqkv, B_wo)
    return x
```

```asm
; @launch kernel=prep_kernel grid=(256,1,1) block=(256,1,1) lds=0
; @launch kernel=main_kernel grid=(256,1,1) block=(512,1,1) lds=163840
.amdgcn_target "amdgcn-amd-amdhsa--gfx950"
.text
.globl prep_kernel
.p2align 8
.type prep_kernel,@function
prep_kernel:
  s_cmp_ge_u32 s2, 256
  s_cbranch_scc1 L_k0_end
  s_load_dwordx4 s[16:19], s[0:1], 0
  s_load_dwordx2 s[20:21], s[0:1], 24
  s_load_dwordx4 s[24:27], s[0:1], 40
  s_load_dwordx2 s[28:29], s[0:1], 72
  v_lshrrev_b32 v1, 6, v0
  v_and_b32 v2, 63, v0
  v_readfirstlane_b32 s30, v1
  v_lshlrev_b32 v3, 4, v2
  v_lshrrev_b32 v4, 4, v2
  v_and_b32 v5, 15, v2
  v_mov_b32 v6, 1.0
  v_mov_b32 v7, 0x3f803f80
  s_getpc_b64 s[46:47]
L_k0_pc:
  s_add_u32 s48, s46, main_kernel-L_k0_pc
  s_addc_u32 s49, s47, 0
  s_mov_b32 s50, L_code_end-main_kernel
  s_mov_b32 s51, 0x20000
  v_lshlrev_b32 v110, 7, v0
  buffer_load_dword v111, v110, s[48:51], 0 offen
  s_waitcnt lgkmcnt(0)
  s_mov_b32 s4, s28
  s_mov_b32 s5, s29
  s_mov_b32 s6, 67108864
  s_mov_b32 s7, 0x20000
  s_cmp_ge_u32 s30, 2
  s_cbranch_scc1 L_k0_x
  s_lshl_b32 s31, s2, 1
  s_add_u32 s31, s31, s30
  s_lshr_b32 s32, s31, 5
  s_and_b32 s33, s31, 31
  s_mov_b32 s11, 0x20000
  s_cmp_ge_u32 s33, 24
  s_cbranch_scc1 L_k0_wo
  s_cmp_ge_u32 s33, 12
  s_cselect_b32 s8, s24, s18
  s_cselect_b32 s9, s25, s19
  s_cselect_b32 s34, 12, 0
  s_cselect_b32 s35, 1572864, 0
  s_cselect_b32 s44, 98304, 0
  s_sub_u32 s33, s33, s34
  s_add_u32 s44, s44, 22020096
  s_mov_b32 s10, 0x180000
  s_mov_b32 s36, 3072
  s_and_b32 s37, s33, 3
  s_mul_i32 s37, s37, 393216
  s_add_u32 s35, s35, s37
  s_mul_i32 s37, s32, 6144
  s_add_u32 s35, s35, s37
  s_add_u32 s44, s44, s37
  s_lshr_b32 s37, s33, 2
  s_lshl_b32 s37, s37, 11
  s_add_u32 s35, s35, s37
  s_lshl_b32 s37, s33, 9
  s_add_u32 s44, s44, s37
  v_lshrrev_b32 v8, 2, v5
  v_mul_u32_u24 v8, 98304, v8
  v_bfe_u32 v9, v5, 1, 1
  v_lshlrev_b32 v9, 10, v9
  v_add_u32 v8, v8, v9
  s_mov_b32 s45, 1
  s_branch L_k0_wcommon
L_k0_wo:
  s_cmp_ge_u32 s33, 28
  s_cselect_b32 s8, s26, s20
  s_cselect_b32 s9, s27, s21
  s_cselect_b32 s34, 28, 24
  s_cselect_b32 s35, 524288, 0
  s_sub_u32 s33, s33, s34
  s_add_u32 s35, s35, 3145728
  s_mov_b32 s10, 0x80000
  s_mov_b32 s36, 1024
  s_lshl_b32 s37, s33, 17
  s_add_u32 s35, s35, s37
  s_lshl_b32 s37, s32, 11
  s_add_u32 s35, s35, s37
  v_lshrrev_b32 v8, 2, v5
  v_lshlrev_b32 v8, 15, v8
  v_bfe_u32 v9, v5, 1, 1
  v_lshlrev_b32 v9, 10, v9
  v_add_u32 v8, v8, v9
  s_mov_b32 s45, 0
L_k0_wcommon:
  v_lshlrev_b32 v9, 8, v4
  v_add_u32 v8, v8, v9
  v_and_b32 v9, 1, v5
  v_lshlrev_b32 v9, 7, v9
  v_add_u32 v8, v8, v9
  s_lshl_b32 s37, s36, 2
  v_mul_lo_u32 v9, s37, v4
  v_lshlrev_b32 v10, 4, v5
  v_add_u32 v9, v9, v10
  s_lshl_b32 s37, s36, 5
  s_mul_i32 s38, s32, s37
  s_lshl_b32 s37, s33, 8
  s_add_u32 s38, s38, s37
  s_lshl_b32 s39, s36, 4
  s_mov_b32 s40, s38
  buffer_load_dwordx4 v[16:19], v9, s[8:11], s40 offen
  s_add_u32 s40, s40, s36
  buffer_load_dwordx4 v[20:23], v9, s[8:11], s40 offen
  s_add_u32 s40, s40, s36
  buffer_load_dwordx4 v[24:27], v9, s[8:11], s40 offen
  s_add_u32 s40, s40, s36
  buffer_load_dwordx4 v[28:31], v9, s[8:11], s40 offen
  s_add_u32 s40, s38, s39
  buffer_load_dwordx4 v[32:35], v9, s[8:11], s40 offen
  s_add_u32 s40, s40, s36
  buffer_load_dwordx4 v[36:39], v9, s[8:11], s40 offen
  s_add_u32 s40, s40, s36
  buffer_load_dwordx4 v[40:43], v9, s[8:11], s40 offen
  s_add_u32 s40, s40, s36
  buffer_load_dwordx4 v[44:47], v9, s[8:11], s40 offen
  v_mov_b32 v11, 0x05040100
  v_mov_b32 v12, 0x07060302
  v_mov_b32 v48, -1
  v_mov_b32 v49, -1
  v_mov_b32 v50, -1
  v_mov_b32 v51, -1
  s_cmp_eq_u32 s30, 0
  s_cbranch_scc0 L_k0_arm1
  s_lshl_b32 s41, s2, 12
  s_add_u32 s41, s41, 23068672
  buffer_store_dwordx4 v[48:51], v3, s[4:7], s41 offen
  buffer_store_dwordx4 v[48:51], v3, s[4:7], s41 offen offset:1024
  buffer_store_dwordx4 v[48:51], v3, s[4:7], s41 offen offset:2048
  buffer_store_dwordx4 v[48:51], v3, s[4:7], s41 offen offset:3072
  s_branch L_k0_arm2
L_k0_arm1:
  s_lshl_b32 s41, s2, 12
  s_add_u32 s41, s41, 27262976
  buffer_store_dwordx4 v[48:51], v3, s[4:7], s41 offen
  buffer_store_dwordx4 v[48:51], v3, s[4:7], s41 offen offset:1024
  buffer_store_dwordx4 v[48:51], v3, s[4:7], s41 offen offset:2048
  buffer_store_dwordx4 v[48:51], v3, s[4:7], s41 offen offset:3072
  s_lshl_b32 s41, s2, 9
  s_add_u32 s41, s41, 24117248
  s_mov_b64 exec, 0xffffffff
  buffer_store_dwordx4 v[48:51], v3, s[4:7], s41 offen
  s_lshl_b32 s41, s2, 8
  s_add_u32 s41, s41, 29360128
  s_mov_b64 exec, 0xffff
  buffer_store_dwordx4 v[48:51], v3, s[4:7], s41 offen
  s_mov_b64 exec, -1
L_k0_arm2:
  s_waitcnt vmcnt(0)
  v_perm_b32 v48, v20, v16, v11
  v_perm_b32 v49, v28, v24, v11
  v_perm_b32 v50, v36, v32, v11
  v_perm_b32 v51, v44, v40, v11
  buffer_store_dwordx4 v[48:51], v8, s[4:7], s35 offen offset:0
  v_perm_b32 v52, v20, v16, v12
  v_perm_b32 v53, v28, v24, v12
  v_perm_b32 v54, v36, v32, v12
  v_perm_b32 v55, v44, v40, v12
  buffer_store_dwordx4 v[52:55], v8, s[4:7], s35 offen offset:16
  v_perm_b32 v56, v21, v17, v11
  v_perm_b32 v57, v29, v25, v11
  v_perm_b32 v58, v37, v33, v11
  v_perm_b32 v59, v45, v41, v11
  buffer_store_dwordx4 v[56:59], v8, s[4:7], s35 offen offset:32
  v_perm_b32 v60, v21, v17, v12
  v_perm_b32 v61, v29, v25, v12
  v_perm_b32 v62, v37, v33, v12
  v_perm_b32 v63, v45, v41, v12
  buffer_store_dwordx4 v[60:63], v8, s[4:7], s35 offen offset:48
  v_perm_b32 v64, v22, v18, v11
  v_perm_b32 v65, v30, v26, v11
  v_perm_b32 v66, v38, v34, v11
  v_perm_b32 v67, v46, v42, v11
  buffer_store_dwordx4 v[64:67], v8, s[4:7], s35 offen offset:64
  v_perm_b32 v68, v22, v18, v12
  v_perm_b32 v69, v30, v26, v12
  v_perm_b32 v70, v38, v34, v12
  v_perm_b32 v71, v46, v42, v12
  buffer_store_dwordx4 v[68:71], v8, s[4:7], s35 offen offset:80
  v_perm_b32 v72, v23, v19, v11
  v_perm_b32 v73, v31, v27, v11
  v_perm_b32 v74, v39, v35, v11
  v_perm_b32 v75, v47, v43, v11
  buffer_store_dwordx4 v[72:75], v8, s[4:7], s35 offen offset:96
  v_perm_b32 v76, v23, v19, v12
  v_perm_b32 v77, v31, v27, v12
  v_perm_b32 v78, v39, v35, v12
  v_perm_b32 v79, v47, v43, v12
  buffer_store_dwordx4 v[76:79], v8, s[4:7], s35 offen offset:112
  s_cmp_eq_u32 s45, 0
  s_cbranch_scc1 L_k0_end
  v_dot2_f32_bf16 v16, v48, v7, 0
  v_dot2_f32_bf16 v17, v52, v7, 0
  v_dot2_f32_bf16 v18, v56, v7, 0
  v_dot2_f32_bf16 v19, v60, v7, 0
  v_dot2_f32_bf16 v20, v64, v7, 0
  v_dot2_f32_bf16 v21, v68, v7, 0
  v_dot2_f32_bf16 v22, v72, v7, 0
  v_dot2_f32_bf16 v23, v76, v7, 0
  v_dot2_f32_bf16 v16, v49, v7, v16
  v_dot2_f32_bf16 v17, v53, v7, v17
  v_dot2_f32_bf16 v18, v57, v7, v18
  v_dot2_f32_bf16 v19, v61, v7, v19
  v_dot2_f32_bf16 v20, v65, v7, v20
  v_dot2_f32_bf16 v21, v69, v7, v21
  v_dot2_f32_bf16 v22, v73, v7, v22
  v_dot2_f32_bf16 v23, v77, v7, v23
  v_dot2_f32_bf16 v16, v50, v7, v16
  v_dot2_f32_bf16 v17, v54, v7, v17
  v_dot2_f32_bf16 v18, v58, v7, v18
  v_dot2_f32_bf16 v19, v62, v7, v19
  v_dot2_f32_bf16 v20, v66, v7, v20
  v_dot2_f32_bf16 v21, v70, v7, v21
  v_dot2_f32_bf16 v22, v74, v7, v22
  v_dot2_f32_bf16 v23, v78, v7, v23
  v_dot2_f32_bf16 v16, v51, v7, v16
  v_dot2_f32_bf16 v17, v55, v7, v17
  v_dot2_f32_bf16 v18, v59, v7, v18
  v_dot2_f32_bf16 v19, v63, v7, v19
  v_dot2_f32_bf16 v20, v67, v7, v20
  v_dot2_f32_bf16 v21, v71, v7, v21
  v_dot2_f32_bf16 v22, v75, v7, v22
  v_dot2_f32_bf16 v23, v79, v7, v23
  v_mfma_f32_16x16x4_f32 v[80:83], v6, v16, 0
  v_mfma_f32_16x16x4_f32 v[84:87], v6, v17, 0
  v_mfma_f32_16x16x4_f32 v[88:91], v6, v18, 0
  v_mfma_f32_16x16x4_f32 v[92:95], v6, v19, 0
  v_mfma_f32_16x16x4_f32 v[96:99], v6, v20, 0
  v_mfma_f32_16x16x4_f32 v[100:103], v6, v21, 0
  v_mfma_f32_16x16x4_f32 v[104:107], v6, v22, 0
  v_mfma_f32_16x16x4_f32 v[108:111], v6, v23, 0
  s_nop 2
  v_mov_b32 v24, v80
  v_mov_b32 v25, v84
  v_mov_b32 v26, v88
  v_mov_b32 v27, v92
  v_mov_b32 v28, v96
  v_mov_b32 v29, v100
  v_mov_b32 v30, v104
  v_mov_b32 v31, v108
  v_lshlrev_b32 v9, 5, v5
  s_mov_b64 exec, 0xffff
  buffer_store_dwordx4 v[24:27], v9, s[4:7], s44 offen
  buffer_store_dwordx4 v[28:31], v9, s[4:7], s44 offen offset:16
  s_endpgm
  s_nop 15
  s_nop 3
L_k0_x:
  s_mov_b32 s8, s16
  s_mov_b32 s9, s17
  s_mov_b32 s10, 0x200000
  s_mov_b32 s11, 0x20000
  s_and_b32 s31, s2, 7
  s_lshr_b32 s32, s2, 3
  s_lshl_b32 s32, s32, 1
  s_add_u32 s32, s32, s30
  s_sub_u32 s32, s32, 2
  s_lshl_b32 s33, s31, 4
  s_lshr_b32 s34, s32, 2
  s_add_u32 s33, s33, s34
  s_and_b32 s34, s32, 3
  s_lshr_b32 s35, s33, 1
  s_lshl_b32 s35, s35, 5
  s_and_b32 s36, s33, 1
  s_add_u32 s35, s35, s36
  s_lshl_b32 s35, s35, 10
  s_lshl_b32 s36, s34, 8
  s_add_u32 s35, s35, s36
  v_lshlrev_b32 v8, 11, v5
  v_lshlrev_b32 v9, 3, v4
  v_add_u32 v8, v8, v9
  buffer_load_dwordx2 v[16:17], v8, s[8:11], s35 offen offset:0
  buffer_load_dwordx2 v[18:19], v8, s[8:11], s35 offen offset:32
  buffer_load_dwordx2 v[20:21], v8, s[8:11], s35 offen offset:64
  buffer_load_dwordx2 v[22:23], v8, s[8:11], s35 offen offset:96
  buffer_load_dwordx2 v[24:25], v8, s[8:11], s35 offen offset:128
  buffer_load_dwordx2 v[26:27], v8, s[8:11], s35 offen offset:160
  buffer_load_dwordx2 v[28:29], v8, s[8:11], s35 offen offset:192
  buffer_load_dwordx2 v[30:31], v8, s[8:11], s35 offen offset:224
  v_mov_b32 v40, 0
  v_mov_b32 v41, 0
  v_mov_b32 v42, 0
  v_mov_b32 v43, 0
  s_lshl_b32 s36, s2, 10
  s_add_u32 s36, s36, 22282240
  s_cmp_eq_u32 s30, 2
  s_cbranch_scc0 L_k0_nozero
  buffer_store_dwordx4 v[40:43], v3, s[4:7], s36 offen
L_k0_nozero:
  s_lshl_b32 s36, s33, 14
  s_lshl_b32 s37, s34, 12
  s_add_u32 s36, s36, s37
  s_add_u32 s36, s36, 4194304
  s_lshl_b32 s37, s33, 11
  s_lshl_b32 s38, s34, 9
  s_add_u32 s37, s37, s38
  s_add_u32 s37, s37, 20971520
  v_mov_b32 v44, -1
  v_mov_b32 v45, -1
  v_mov_b32 v46, -1
  v_mov_b32 v47, -1
  s_add_u32 s38, s36, 0x200000
  s_add_u32 s39, s36, 8388608
  s_add_u32 s40, s37, 0x40000
  buffer_store_dwordx4 v[44:47], v3, s[4:7], s38 offen offset:0
  buffer_store_dwordx4 v[44:47], v3, s[4:7], s39 offen offset:0
  buffer_store_dwordx4 v[44:47], v3, s[4:7], s38 offen offset:1024
  buffer_store_dwordx4 v[44:47], v3, s[4:7], s39 offen offset:1024
  buffer_store_dwordx4 v[44:47], v3, s[4:7], s38 offen offset:2048
  buffer_store_dwordx4 v[44:47], v3, s[4:7], s39 offen offset:2048
  buffer_store_dwordx4 v[44:47], v3, s[4:7], s38 offen offset:3072
  buffer_store_dwordx4 v[44:47], v3, s[4:7], s39 offen offset:3072
  s_mov_b64 exec, 0xffffffff
  buffer_store_dwordx4 v[44:47], v3, s[4:7], s40 offen
  s_mov_b64 exec, -1
  s_waitcnt vmcnt(9)
  buffer_store_dwordx4 v[16:19], v3, s[4:7], s36 offen offset:0
  buffer_store_dwordx4 v[20:23], v3, s[4:7], s36 offen offset:1024
  buffer_store_dwordx4 v[24:27], v3, s[4:7], s36 offen offset:2048
  buffer_store_dwordx4 v[28:31], v3, s[4:7], s36 offen offset:3072
  v_dot2_f32_bf16 v48, v16, v7, 0
  v_dot2_f32_bf16 v49, v16, v16, 0
  v_dot2_f32_bf16 v50, v20, v7, 0
  v_dot2_f32_bf16 v51, v20, v20, 0
  v_dot2_f32_bf16 v52, v24, v7, 0
  v_dot2_f32_bf16 v53, v24, v24, 0
  v_dot2_f32_bf16 v54, v28, v7, 0
  v_dot2_f32_bf16 v55, v28, v28, 0
  v_dot2_f32_bf16 v48, v17, v7, v48
  v_dot2_f32_bf16 v49, v17, v17, v49
  v_dot2_f32_bf16 v50, v21, v7, v50
  v_dot2_f32_bf16 v51, v21, v21, v51
  v_dot2_f32_bf16 v52, v25, v7, v52
  v_dot2_f32_bf16 v53, v25, v25, v53
  v_dot2_f32_bf16 v54, v29, v7, v54
  v_dot2_f32_bf16 v55, v29, v29, v55
  v_dot2_f32_bf16 v48, v18, v7, v48
  v_dot2_f32_bf16 v49, v18, v18, v49
  v_dot2_f32_bf16 v50, v22, v7, v50
  v_dot2_f32_bf16 v51, v22, v22, v51
  v_dot2_f32_bf16 v52, v26, v7, v52
  v_dot2_f32_bf16 v53, v26, v26, v53
  v_dot2_f32_bf16 v54, v30, v7, v54
  v_dot2_f32_bf16 v55, v30, v30, v55
  v_dot2_f32_bf16 v48, v19, v7, v48
  v_dot2_f32_bf16 v49, v19, v19, v49
  v_dot2_f32_bf16 v50, v23, v7, v50
  v_dot2_f32_bf16 v51, v23, v23, v51
  v_dot2_f32_bf16 v52, v27, v7, v52
  v_dot2_f32_bf16 v53, v27, v27, v53
  v_dot2_f32_bf16 v54, v31, v7, v54
  v_dot2_f32_bf16 v55, v31, v31, v55
  v_mfma_f32_16x16x4_f32 v[80:83], v6, v48, 0
  v_mfma_f32_16x16x4_f32 v[84:87], v6, v49, 0
  v_mfma_f32_16x16x4_f32 v[88:91], v6, v50, 0
  v_mfma_f32_16x16x4_f32 v[92:95], v6, v51, 0
  v_mfma_f32_16x16x4_f32 v[96:99], v6, v52, 0
  v_mfma_f32_16x16x4_f32 v[100:103], v6, v53, 0
  v_mfma_f32_16x16x4_f32 v[104:107], v6, v54, 0
  v_mfma_f32_16x16x4_f32 v[108:111], v6, v55, 0
  s_nop 2
  v_mov_b32 v56, v80
  v_mov_b32 v57, v84
  v_mov_b32 v58, v88
  v_mov_b32 v59, v92
  v_mov_b32 v60, v96
  v_mov_b32 v61, v100
  v_mov_b32 v62, v104
  v_mov_b32 v63, v108
  s_mov_b64 exec, 0xffff
  buffer_store_dwordx4 v[56:59], v3, s[4:7], s37 offen
  buffer_store_dwordx4 v[60:63], v3, s[4:7], s37 offen offset:256
L_k0_end:
  s_endpgm
.globl main_kernel
.p2align 8
.type main_kernel,@function
main_kernel:
  s_cmp_ge_u32 s2, 256
  s_cbranch_scc1 L_km_end
  s_load_dwordx2 s[16:17], s[0:1], 16
  s_load_dwordx2 s[18:19], s[0:1], 56
  s_load_dwordx2 s[20:21], s[0:1], 72
  v_lshrrev_b32 v200, 6, v0
  v_and_b32 v7, 63, v0
  v_readfirstlane_b32 s32, v200
  v_lshlrev_b32 v1, 4, v7
  v_lshlrev_b32 v14, 2, v7
  v_lshlrev_b32 v15, 7, v7
  v_lshlrev_b32 v235, 10, v7
  v_lshrrev_b32 v201, 4, v7
  v_and_b32 v202, 15, v7
  v_lshlrev_b32 v247, 9, v201
  v_lshlrev_b32 v203, 4, v202
  v_add_u32 v247, v247, v203
  s_and_b32 s30, s2, 7
  s_lshr_b32 s31, s2, 3
  s_lshl_b32 s30, s30, 1
  s_and_b32 s53, s31, 1
  s_add_u32 s30, s30, s53
  s_lshr_b32 s31, s31, 1
  s_lshl_b32 s33, s30, 3
  s_add_u32 s33, s33, s32
  s_mov_b32 s39, 0
  s_mov_b32 s90, 0
  s_mov_b32 s60, 1069066811
  s_mov_b32 s61, 1052289595
  s_mul_i32 s62, s31, 98304
  s_lshl_b32 s63, s31, 15
  s_add_u32 s63, s63, 3145728
  s_lshr_b32 s64, s31, 1
  s_lshl_b32 s64, s64, 8
  s_and_b32 s53, s31, 1
  s_lshl_b32 s53, s53, 3
  s_add_u32 s64, s64, s53
  s_add_u32 s64, s64, 0x40000
  v_cmp_le_u32 vcc, 96, v0
  v_subrev_u32 v205, 96, v0
  s_nop 0
  v_cndmask_b32 v205, v0, v205, vcc
  v_mov_b32 v206, 98304
  v_cndmask_b32 v206, 0, v206, vcc
  v_lshrrev_b32 v207, 5, v205
  v_lshlrev_b32 v207, 11, v207
  v_add_u32 v206, v206, v207
  v_and_b32 v207, 31, v205
  v_lshlrev_b32 v207, 2, v207
  v_add_u32 v206, v206, v207
  v_lshlrev_b32 v203, 7, v201
  v_lshlrev_b32 v204, 1, v202
  v_add_u32 v203, v203, v204
  s_lshl_b32 s53, s39, 21
  s_lshl_b32 s54, s33, 14
  s_add_u32 s53, s53, s54
  s_add_u32 s40, s53, 4194304
  s_add_u32 s43, s53, 12582912
  s_lshl_b32 s55, s31, 10
  s_add_u32 s42, s43, s55
  s_add_u32 s44, s40, s55
  s_add_u32 s44, s44, 0x200000
  s_lshl_b32 s53, s39, 18
  s_lshl_b32 s54, s33, 11
  s_add_u32 s41, s53, s54
  s_add_u32 s41, s41, 20971520
  s_add_u32 s45, s41, s64
  s_lshl_b32 s53, s39, 7
  s_add_u32 s54, s53, s33
  s_lshl_b32 s54, s54, 6
  s_add_u32 s47, s54, 22454272
  s_add_u32 s46, s54, 22487040
  s_add_u32 s49, s46, 8192
  s_lshr_b32 s53, s39, 1
  s_lshl_b32 s54, s53, 4
  s_add_u32 s54, s54, s31
  s_lshl_b32 s50, s54, 12
  s_add_u32 s50, s50, 29360128
  s_lshl_b32 s51, s54, 16
  s_add_u32 s51, s51, 27262976
  s_and_b32 s53, s39, 1
  s_cmp_eq_u32 s53, 0
  s_cselect_b32 s66, 0, 524288
  s_cselect_b32 s68, 524288, 0
  s_cselect_b32 s67, 1572864, 0
  s_cselect_b32 s65, s30, 0
  s_add_u32 s66, s66, s63
  s_add_u32 s68, s68, s63
  s_add_u32 s67, s67, s62
  s_waitcnt lgkmcnt(0)
  s_mov_b32 s4, s20
  s_mov_b32 s5, s21
  s_mov_b32 s6, 67108864
  s_mov_b32 s7, 0x20000
  s_mov_b32 s8, s18
  s_mov_b32 s9, s19
  s_mov_b32 s10, 0x200000
  s_mov_b32 s11, 0x20000
  s_mov_b32 s12, s16
  s_mov_b32 s13, s17
  s_mov_b32 s14, 16384
  s_mov_b32 s15, 0x20000
  s_getreg_b32 s74, hwreg(HW_REG_XCC_ID)
  s_and_b32 s74, s74, 15
  s_add_u32 s74, s74, 1
  s_lshl_b32 s75, s30, 6
  s_add_u32 s75, s75, 22429696
  s_cmp_lg_u32 s32, 0
  s_cbranch_scc1 L_noxid
  s_lshl_b32 s53, s31, 2
  s_add_u32 s53, s53, s75
  v_mov_b32 v208, s74
  v_mov_b32 v209, 0
  s_mov_b64 exec, 1
  buffer_store_dword v208, v209, s[4:7], s53 offen sc1
  s_mov_b64 exec, -1
L_noxid:
  s_mul_i32 s53, s32, 12288
  s_add_u32 s52, s62, s53
  s_add_u32 s54, s53, 2048
  s_add_u32 s55, s52, 2048
  s_mov_b32 m0, s54
  s_nop 0
  buffer_load_dwordx4 v1, s[4:7], s55 offen offset:0 lds
  buffer_load_dwordx4 v1, s[4:7], s55 offen offset:1024 lds
  buffer_load_dwordx4 v1, s[4:7], s55 offen offset:2048 lds
  buffer_load_dwordx4 v1, s[4:7], s55 offen offset:3072 lds
  s_add_u32 s54, s54, 6144
  s_add_u32 s55, s55, 6144
  s_mov_b32 m0, s54
  s_nop 0
  buffer_load_dwordx4 v1, s[4:7], s55 offen offset:0 lds
  buffer_load_dwordx4 v1, s[4:7], s55 offen offset:1024 lds
  buffer_load_dwordx4 v1, s[4:7], s55 offen offset:2048 lds
  buffer_load_dwordx4 v1, s[4:7], s55 offen offset:3072 lds
  s_mov_b32 s88, s52
  s_mov_b32 s89, s53
  buffer_load_dwordx4 v[64:67], v1, s[4:7], s40 offen offset:0 sc1
  buffer_load_dwordx4 v[68:71], v1, s[4:7], s40 offen offset:1024 sc1
  buffer_load_dwordx4 v[72:75], v1, s[4:7], s40 offen offset:2048 sc1
  buffer_load_dwordx4 v[76:79], v1, s[4:7], s40 offen offset:3072 sc1
  s_add_u32 s58, s40, 4096
  buffer_load_dwordx4 v[80:83], v1, s[4:7], s58 offen offset:0 sc1
  buffer_load_dwordx4 v[84:87], v1, s[4:7], s58 offen offset:1024 sc1
  buffer_load_dwordx4 v[88:91], v1, s[4:7], s58 offen offset:2048 sc1
  buffer_load_dwordx4 v[92:95], v1, s[4:7], s58 offen offset:3072 sc1
  s_lshl_b32 s53, s31, 7
  s_add_u32 s53, s53, 22020096
  s_cmp_ge_u32 s32, 3
  s_cbranch_scc1 L_cs_skip1
  buffer_load_dword v152, v206, s[4:7], s53 offen
  s_add_u32 s53, s53, 6144
  buffer_load_dword v153, v206, s[4:7], s53 offen
  s_add_u32 s53, s53, 6144
  buffer_load_dword v154, v206, s[4:7], s53 offen
  s_add_u32 s53, s53, 6144
  buffer_load_dword v155, v206, s[4:7], s53 offen
  s_add_u32 s53, s53, 6144
  buffer_load_dword v156, v206, s[4:7], s53 offen
  s_add_u32 s53, s53, 6144
  buffer_load_dword v157, v206, s[4:7], s53 offen
  s_add_u32 s53, s53, 6144
  buffer_load_dword v158, v206, s[4:7], s53 offen
  s_add_u32 s53, s53, 6144
  buffer_load_dword v159, v206, s[4:7], s53 offen
  s_add_u32 s53, s53, 6144
  buffer_load_dword v160, v206, s[4:7], s53 offen
  s_add_u32 s53, s53, 6144
  buffer_load_dword v161, v206, s[4:7], s53 offen
  s_add_u32 s53, s53, 6144
  buffer_load_dword v162, v206, s[4:7], s53 offen
  s_add_u32 s53, s53, 6144
  buffer_load_dword v163, v206, s[4:7], s53 offen
  s_add_u32 s53, s53, 6144
  buffer_load_dword v164, v206, s[4:7], s53 offen
  s_add_u32 s53, s53, 6144
  buffer_load_dword v165, v206, s[4:7], s53 offen
  s_add_u32 s53, s53, 6144
  buffer_load_dword v166, v206, s[4:7], s53 offen
  s_add_u32 s53, s53, 6144
  buffer_load_dword v167, v206, s[4:7], s53 offen
L_cs_skip1:
  s_lshl_b32 s53, s31, 10
  buffer_load_ushort v168, v203, s[12:15], s53 offen offset:0
  buffer_load_ushort v169, v203, s[12:15], s53 offen offset:32
  buffer_load_ushort v170, v203, s[12:15], s53 offen offset:64
  buffer_load_ushort v171, v203, s[12:15], s53 offen offset:96
  buffer_load_ushort v172, v203, s[12:15], s53 offen offset:512
  buffer_load_ushort v173, v203, s[12:15], s53 offen offset:544
  buffer_load_ushort v174, v203, s[12:15], s53 offen offset:576
  buffer_load_ushort v175, v203, s[12:15], s53 offen offset:608
  s_mov_b32 m0, s89
  s_nop 0
  buffer_load_dwordx4 v1, s[4:7], s88 offen offset:0 lds
  buffer_load_dwordx4 v1, s[4:7], s88 offen offset:1024 lds
  s_add_u32 s88, s88, 6144
  s_add_u32 s89, s89, 6144
  s_mov_b32 m0, s89
  s_nop 0
  buffer_load_dwordx4 v1, s[4:7], s88 offen offset:0 lds
  buffer_load_dwordx4 v1, s[4:7], s88 offen offset:1024 lds
  s_sub_u32 s53, s44, 0x200000
  buffer_load_dwordx4 v[52:55], v1, s[4:7], s53 offen
  v_lshlrev_b32 v246, 4, v201
  s_cmp_ge_u32 s32, 4
  s_cbranch_scc1 L_noarm2
  v_mov_b32 v128, -1
  v_mov_b32 v129, -1
  v_mov_b32 v130, -1
  v_mov_b32 v131, -1
  s_lshl_b32 s53, s32, 14
  s_lshl_b32 s54, s30, 10
  s_add_u32 s53, s53, s54
  s_add_u32 s53, s53, s51
  s_add_u32 s53, s53, 0x100000
  buffer_store_dwordx4 v[128:131], v1, s[4:7], s53 offen sc1
  s_lshl_b32 s53, s32, 6
  s_lshl_b32 s54, s30, 8
  s_add_u32 s53, s53, s54
  s_add_u32 s53, s53, s50
  s_add_u32 s53, s53, 0x10000
  s_mov_b32 s54, 0x00010001
  s_mov_b32 s55, 0x00010001
  s_mov_b64 exec, s[54:55]
  buffer_store_dwordx4 v[128:131], v246, s[4:7], s53 offen sc1
  s_mov_b64 exec, -1
L_noarm2:
  v_add_u32 v2, 49152, v1
  v_add_u32 v3, 98304, v1
  v_add_u32 v234, 131072, v1
  v_mov_b32 v4, 0
  v_mov_b32 v5, 1
  v_mov_b32 v6, 1.0
  v_mov_b32 v248, 0x3f803f80
  v_mov_b32 v249, 0x3f803f80
  v_mov_b32 v250, 0x3f803f80
  v_mov_b32 v251, 0x3f803f80
  v_xor_b32 v244, 32, v7
  v_lshlrev_b32 v244, 2, v244
  v_xor_b32 v245, 48, v7
  v_lshlrev_b32 v245, 2, v245
  v_lshlrev_b32 v246, 4, v201
  v_lshlrev_b32 v203, 2, v201
  v_sub_u32 v203, v202, v203
  v_mov_b32 v204, 0x3f80
  v_mov_b32 v205, 0x3f800000
  v_cmp_eq_u32 vcc, 0, v203
  s_nop 1
  v_cndmask_b32 v8, 0, v204, vcc
  v_cmp_eq_u32 vcc, 1, v203
  s_nop 1
  v_cndmask_b32 v8, v8, v205, vcc
  v_cmp_eq_u32 vcc, 2, v203
  s_nop 1
  v_cndmask_b32 v9, 0, v204, vcc
  v_cmp_eq_u32 vcc, 3, v203
  s_nop 1
  v_cndmask_b32 v9, v9, v205, vcc
  v_mov_b32 v204, 0xf149f2ca
  s_cmp_lt_u32 s33, 2
  s_cselect_b32 s53, -100, -9
  v_subrev_u32 v205, 0, v203
  v_cmp_gt_u32 vcc, 8, v205
  s_nop 1
  v_cndmask_b32 v56, v204, 0, vcc
  v_cmp_ge_i32 vcc, s53, v205
  s_nop 1
  v_cndmask_b32 v60, v204, 0, vcc
  v_subrev_u32 v205, 1, v203
  v_cmp_gt_u32 vcc, 8, v205
  s_nop 1
  v_cndmask_b32 v57, v204, 0, vcc
  v_cmp_ge_i32 vcc, s53, v205
  s_nop 1
  v_cndmask_b32 v61, v204, 0, vcc
  v_subrev_u32 v205, 2, v203
  v_cmp_gt_u32 vcc, 8, v205
  s_nop 1
  v_cndmask_b32 v58, v204, 0, vcc
  v_cmp_ge_i32 vcc, s53, v205
  s_nop 1
  v_cndmask_b32 v62, v204, 0, vcc
  v_subrev_u32 v205, 3, v203
  v_cmp_gt_u32 vcc, 8, v205
  s_nop 1
  v_cndmask_b32 v59, v204, 0, vcc
  v_cmp_ge_i32 vcc, s53, v205
  s_nop 1
  v_cndmask_b32 v63, v204, 0, vcc
  s_waitcnt vmcnt(5)
  v_lshl_or_b32 v10, v169, 16, v168
  v_lshl_or_b32 v11, v171, 16, v170
  v_lshl_or_b32 v12, v173, 16, v172
  v_lshl_or_b32 v13, v175, 16, v174
  s_cmp_ge_u32 s32, 3
  s_cbranch_scc1 L_cs_skip2
  v_add_f32 v152, v152, v160
  v_add_f32 v153, v153, v161
  v_add_f32 v154, v154, v162
  v_add_f32 v155, v155, v163
  v_add_f32 v156, v156, v164
  v_add_f32 v157, v157, v165
  v_add_f32 v158, v158, v166
  v_add_f32 v159, v159, v167
  v_add_f32 v152, v152, v156
  v_add_f32 v153, v153, v157
  v_add_f32 v154, v154, v158
  v_add_f32 v155, v155, v159
  v_add_f32 v152, v152, v154
  v_add_f32 v153, v153, v155
  v_add_f32 v152, v152, v153
  v_lshlrev_b32 v205, 2, v0
  v_add_u32 v205, 159744, v205
  ds_write_b32 v205, v152
  s_waitcnt lgkmcnt(0)
L_cs_skip2:
  s_barrier
  v_add_u32 v205, 159744, v246
  v_lshlrev_b32 v206, 2, v202
  v_add_u32 v206, 159744, v206
  ds_read_b128 v[16:19], v205 offset:0
  ds_read_b128 v[20:23], v205 offset:64
  ds_read_b128 v[24:27], v205 offset:128
  ds_read_b128 v[28:31], v205 offset:192
  ds_read_b32 v32, v206 offset:256
  ds_read_b32 v33, v206 offset:320
  ds_read_b128 v[34:37], v205 offset:384
  ds_read_b128 v[38:41], v205 offset:448
  ds_read_b128 v[42:45], v205 offset:512
  ds_read_b128 v[46:49], v205 offset:576
  ds_read_b32 v50, v206 offset:640
  ds_read_b32 v51, v206 offset:704
  s_branch L_A_entry
  s_nop 15
  s_nop 3
L_layer:
  s_lshl_b32 s53, s39, 21
  s_lshl_b32 s54, s33, 14
  s_add_u32 s53, s53, s54
  s_add_u32 s40, s53, 4194304
  s_add_u32 s43, s53, 12582912
  s_lshl_b32 s55, s31, 10
  s_add_u32 s42, s43, s55
  s_add_u32 s44, s40, s55
  s_add_u32 s44, s44, 0x200000
  s_lshl_b32 s53, s39, 18
  s_lshl_b32 s54, s33, 11
  s_add_u32 s41, s53, s54
  s_add_u32 s41, s41, 20971520
  s_add_u32 s45, s41, s64
  s_lshl_b32 s53, s39, 7
  s_add_u32 s54, s53, s33
  s_lshl_b32 s54, s54, 6
  s_add_u32 s47, s54, 22454272
  s_add_u32 s46, s54, 22487040
  s_add_u32 s49, s46, 8192
  s_lshr_b32 s53, s39, 1
  s_lshl_b32 s54, s53, 4
  s_add_u32 s54, s54, s31
  s_lshl_b32 s50, s54, 12
  s_add_u32 s50, s50, 29360128
  s_lshl_b32 s51, s54, 16
  s_add_u32 s51, s51, 27262976
  s_and_b32 s53, s39, 1
  s_cmp_eq_u32 s53, 0
  s_cselect_b32 s66, 0, 524288
  s_cselect_b32 s68, 524288, 0
  s_cselect_b32 s67, 1572864, 0
  s_cselect_b32 s65, s30, 0
  s_add_u32 s66, s66, s63
  s_add_u32 s68, s68, s63
  s_add_u32 s67, s67, s62
  s_barrier
  buffer_load_dwordx4 v[64:67], v1, s[4:7], s40 offen offset:0 sc1
  buffer_load_dwordx4 v[68:71], v1, s[4:7], s40 offen offset:1024 sc1
  buffer_load_dwordx4 v[72:75], v1, s[4:7], s40 offen offset:2048 sc1
  buffer_load_dwordx4 v[76:79], v1, s[4:7], s40 offen offset:3072 sc1
  s_add_u32 s58, s40, 4096
  buffer_load_dwordx4 v[80:83], v1, s[4:7], s58 offen offset:0 sc1
  buffer_load_dwordx4 v[84:87], v1, s[4:7], s58 offen offset:1024 sc1
  buffer_load_dwordx4 v[88:91], v1, s[4:7], s58 offen offset:2048 sc1
  buffer_load_dwordx4 v[92:95], v1, s[4:7], s58 offen offset:3072 sc1
  s_and_b32 s53, s39, 1
  s_cmp_eq_u32 s53, 1
  s_cbranch_scc1 L_B
L_A_entry:
  ds_read_b128 v[152:155], v1 offset:2048
  ds_read_b128 v[156:159], v1 offset:3072
  ds_read_b128 v[160:163], v1 offset:4096
  ds_read_b128 v[164:167], v1 offset:5120
  ds_read_b128 v[168:171], v1 offset:8192
  ds_read_b128 v[172:175], v1 offset:9216
  ds_read_b128 v[176:179], v1 offset:10240
  ds_read_b128 v[180:183], v1 offset:11264
  s_waitcnt vmcnt(4)
  s_mov_b32 s56, 0
L_chk_1:
  v_max3_u32 v255, v64, v65, v66
  v_max3_u32 v255, v255, v67, v68
  v_max3_u32 v255, v255, v69, v70
  v_max3_u32 v255, v255, v71, v72
  v_max3_u32 v255, v255, v73, v74
  v_max3_u32 v255, v255, v75, v76
  v_max3_u32 v255, v255, v77, v78
  v_max_u32 v255, v255, v79
  v_cmp_eq_u32 vcc, -1, v255
  s_cbranch_vccnz L_rt_2
L_cd_3:
  s_add_u32 s58, s40, 8192
  buffer_load_dwordx4 v[96:99], v1, s[4:7], s58 offen offset:0 sc1
  buffer_load_dwordx4 v[100:103], v1, s[4:7], s58 offen offset:1024 sc1
  buffer_load_dwordx4 v[104:107], v1, s[4:7], s58 offen offset:2048 sc1
  buffer_load_dwordx4 v[108:111], v1, s[4:7], s58 offen offset:3072 sc1
  buffer_load_dwordx4 v[224:227], v247, s[4:7], s41 offen sc1
  buffer_load_dwordx4 v[228:231], v247, s[4:7], s41 offen offset:256 sc1
  s_waitcnt lgkmcnt(7)
  v_mfma_f32_16x16x32_bf16 v[128:131], v[152:155], v[64:67], 0
  ds_read_b128 v[184:187], v1 offset:14336
  s_waitcnt lgkmcnt(7)
  v_mfma_f32_16x16x32_bf16 v[132:135], v[156:159], v[64:67], 0
  ds_read_b128 v[152:155], v1 offset:15360
  s_waitcnt lgkmcnt(7)
  v_mfma_f32_16x16x32_bf16 v[136:139], v[64:67], v[160:163], 0
  ds_read_b128 v[156:159], v1 offset:16384
  s_waitcnt lgkmcnt(7)
  v_mfma_f32_16x16x32_bf16 v[140:143], v[64:67], v[164:167], 0
  ds_read_b128 v[160:163], v1 offset:17408
  s_waitcnt lgkmcnt(7)
  v_mfma_f32_16x16x32_bf16 v[128:131], v[168:171], v[68:71], v[128:131]
  ds_read_b128 v[164:167], v1 offset:20480
  s_waitcnt lgkmcnt(7)
  v_mfma_f32_16x16x32_bf16 v[132:135], v[172:175], v[68:71], v[132:135]
  ds_read_b128 v[168:171], v1 offset:21504
  s_waitcnt lgkmcnt(7)
  v_mfma_f32_16x16x32_bf16 v[136:139], v[68:71], v[176:179], v[136:139]
  ds_read_b128 v[172:175], v1 offset:22528
  s_waitcnt lgkmcnt(7)
  v_mfma_f32_16x16x32_bf16 v[140:143], v[68:71], v[180:183], v[140:143]
  ds_read_b128 v[176:179], v1 offset:23552
  s_waitcnt lgkmcnt(7)
  v_mfma_f32_16x16x32_bf16 v[128:131], v[184:187], v[72:75], v[128:131]
  ds_read_b128 v[180:183], v1 offset:26624
  s_waitcnt lgkmcnt(7)
  v_mfma_f32_16x16x32_bf16 v[132:135], v[152:155], v[72:75], v[132:135]
  ds_read_b128 v[184:187], v1 offset:27648
  s_waitcnt lgkmcnt(7)
  v_mfma_f32_16x16x32_bf16 v[136:139], v[72:75], v[156:159], v[136:139]
  ds_read_b128 v[152:155], v1 offset:28672
  s_waitcnt lgkmcnt(7)
  v_mfma_f32_16x16x32_bf16 v[140:143], v[72:75], v[160:163], v[140:143]
  ds_read_b128 v[156:159], v1 offset:29696
  s_waitcnt lgkmcnt(7)
  v_mfma_f32_16x16x32_bf16 v[128:131], v[164:167], v[76:79], v[128:131]
  ds_read_b128 v[160:163], v1 offset:32768
  s_waitcnt lgkmcnt(7)
  v_mfma_f32_16x16x32_bf16 v[132:135], v[168:171], v[76:79], v[132:135]
  ds_read_b128 v[164:167], v1 offset:33792
  s_waitcnt lgkmcnt(7)
  v_mfma_f32_16x16x32_bf16 v[136:139], v[76:79], v[172:175], v[136:139]
  ds_read_b128 v[168:171], v1 offset:34816
  s_waitcnt lgkmcnt(7)
  v_mfma_f32_16x16x32_bf16 v[140:143], v[76:79], v[176:179], v[140:143]
  ds_read_b128 v[172:175], v1 offset:35840
  s_waitcnt vmcnt(6)
  s_mov_b32 s56, 0
L_chk_4:
  v_max3_u32 v255, v80, v81, v82
  v_max3_u32 v255, v255, v83, v84
  v_max3_u32 v255, v255, v85, v86
  v_max3_u32 v255, v255, v87, v88
  v_max3_u32 v255, v255, v89, v90
  v_max3_u32 v255, v255, v91, v92
  v_max3_u32 v255, v255, v93, v94
  v_max_u32 v255, v255, v95
  v_cmp_eq_u32 vcc, -1, v255
  s_cbranch_vccnz L_rt_5
L_cd_6:
  s_add_u32 s58, s40, 12288
  buffer_load_dwordx4 v[112:115], v1, s[4:7], s58 offen offset:0 sc1
  buffer_load_dwordx4 v[116:119], v1, s[4:7], s58 offen offset:1024 sc1
  buffer_load_dwordx4 v[120:123], v1, s[4:7], s58 offen offset:2048 sc1
  buffer_load_dwordx4 v[124:127], v1, s[4:7], s58 offen offset:3072 sc1
  s_waitcnt lgkmcnt(7)
  v_mfma_f32_16x16x32_bf16 v[128:131], v[180:183], v[80:83], v[128:131]
  ds_read_b128 v[176:179], v1 offset:38912
  s_waitcnt lgkmcnt(7)
  v_mfma_f32_16x16x32_bf16 v[132:135], v[184:187], v[80:83], v[132:135]
  ds_read_b128 v[180:183], v1 offset:39936
  s_waitcnt lgkmcnt(7)
  v_mfma_f32_16x16x32_bf16 v[136:139], v[80:83], v[152:155], v[136:139]
  ds_read_b128 v[184:187], v1 offset:40960
  s_waitcnt lgkmcnt(7)
  v_mfma_f32_16x16x32_bf16 v[140:143], v[80:83], v[156:159], v[140:143]
  ds_read_b128 v[152:155], v1 offset:41984
  s_waitcnt lgkmcnt(7)
  v_mfma_f32_16x16x32_bf16 v[128:131], v[160:163], v[84:87], v[128:131]
  ds_read_b128 v[156:159], v1 offset:45056
  s_waitcnt lgkmcnt(7)
  v_mfma_f32_16x16x32_bf16 v[132:135], v[164:167], v[84:87], v[132:135]
  ds_read_b128 v[160:163], v1 offset:46080
  s_waitcnt lgkmcnt(7)
  v_mfma_f32_16x16x32_bf16 v[136:139], v[84:87], v[168:171], v[136:139]
  ds_read_b128 v[164:167], v1 offset:47104
  s_waitcnt lgkmcnt(7)
  v_mfma_f32_16x16x32_bf16 v[140:143], v[84:87], v[172:175], v[140:143]
  ds_read_b128 v[168:171], v1 offset:48128
  s_waitcnt lgkmcnt(7)
  v_mfma_f32_16x16x32_bf16 v[128:131], v[176:179], v[88:91], v[128:131]
  ds_read_b128 v[172:175], v2 offset:2048
  s_waitcnt lgkmcnt(7)
  v_mfma_f32_16x16x32_bf16 v[132:135], v[180:183], v[88:91], v[132:135]
  ds_read_b128 v[176:179], v2 offset:3072
  s_waitcnt lgkmcnt(7)
  v_mfma_f32_16x16x32_bf16 v[136:139], v[88:91], v[184:187], v[136:139]
  ds_read_b128 v[180:183], v2 offset:4096
  s_waitcnt lgkmcnt(7)
  v_mfma_f32_16x16x32_bf16 v[140:143], v[88:91], v[152:155], v[140:143]
  ds_read_b128 v[184:187], v2 offset:5120
  s_waitcnt lgkmcnt(7)
  v_mfma_f32_16x16x32_bf16 v[128:131], v[156:159], v[92:95], v[128:131]
  ds_read_b128 v[152:155], v2 offset:8192
  s_waitcnt lgkmcnt(7)
  v_mfma_f32_16x16x32_bf16 v[132:135], v[160:163], v[92:95], v[132:135]
  ds_read_b128 v[156:159], v2 offset:9216
  s_waitcnt lgkmcnt(7)
  v_mfma_f32_16x16x32_bf16 v[136:139], v[92:95], v[164:167], v[136:139]
  ds_read_b128 v[160:163], v2 offset:10240
  s_waitcnt lgkmcnt(7)
  v_mfma_f32_16x16x32_bf16 v[140:143], v[92:95], v[168:171], v[140:143]
  ds_read_b128 v[164:167], v2 offset:11264
  s_waitcnt vmcnt(6)
  s_mov_b32 s56, 0
L_chk_7:
  v_max3_u32 v255, v96, v97, v98
  v_max3_u32 v255, v255, v99, v100
  v_max3_u32 v255, v255, v101, v102
  v_max3_u32 v255, v255, v103, v104
  v_max3_u32 v255, v255, v105, v106
  v_max3_u32 v255, v255, v107, v108
  v_max3_u32 v255, v255, v109, v110
  v_max_u32 v255, v255, v111
  v_cmp_eq_u32 vcc, -1, v255
  s_cbranch_vccnz L_rt_8
L_cd_9:
  s_mul_i32 s53, s32, 4096
  s_add_u32 s52, s66, s53
  s_add_u32 s53, s53, 98304
  s_mov_b32 m0, s53
  s_nop 0
  buffer_load_dwordx4 v1, s[4:7], s52 offen offset:0  lds
  buffer_load_dwordx4 v1, s[4:7], s52 offen offset:1024  lds
  buffer_load_dwordx4 v1, s[4:7], s52 offen offset:2048  lds
  buffer_load_dwordx4 v1, s[4:7], s52 offen offset:3072  lds
  s_waitcnt lgkmcnt(7)
  v_mfma_f32_16x16x32_bf16 v[128:131], v[172:175], v[96:99], v[128:131]
  ds_read_b128 v[168:171], v2 offset:14336
  s_waitcnt lgkmcnt(7)
  v_mfma_f32_16x16x32_bf16 v[132:135], v[176:179], v[96:99], v[132:135]
  ds_read_b128 v[172:175], v2 offset:15360
  s_waitcnt lgkmcnt(7)
  v_mfma_f32_16x16x32_bf16 v[136:139], v[96:99], v[180:183], v[136:139]
  ds_read_b128 v[176:179], v2 offset:16384
  s_waitcnt lgkmcnt(7)
  v_mfma_f32_16x16x32_bf16 v[140:143], v[96:99], v[184:187], v[140:143]
  ds_read_b128 v[180:183], v2 offset:17408
  s_waitcnt lgkmcnt(7)
  v_mfma_f32_16x16x32_bf16 v[128:131], v[152:155], v[100:103], v[128:131]
  ds_read_b128 v[184:187], v2 offset:20480
  s_waitcnt lgkmcnt(7)
  v_mfma_f32_16x16x32_bf16 v[132:135], v[156:159], v[100:103], v[132:135]
  ds_read_b128 v[152:155], v2 offset:21504
  s_waitcnt lgkmcnt(7)
  v_mfma_f32_16x16x32_bf16 v[136:139], v[100:103], v[160:163], v[136:139]
  ds_read_b128 v[156:159], v2 offset:22528
  s_waitcnt lgkmcnt(7)
  v_mfma_f32_16x16x32_bf16 v[140:143], v[100:103], v[164:167], v[140:143]
  ds_read_b128 v[160:163], v2 offset:23552
  s_waitcnt lgkmcnt(7)
  v_mfma_f32_16x16x32_bf16 v[128:131], v[168:171], v[104:107], v[128:131]
  ds_read_b128 v[164:167], v2 offset:26624
  s_waitcnt lgkmcnt(7)
  v_mfma_f32_16x16x32_bf16 v[132:135], v[172:175], v[104:107], v[132:135]
  ds_read_b128 v[168:171], v2 offset:27648
  s_waitcnt lgkmcnt(7)
  v_mfma_f32_16x16x32_bf16 v[136:139], v[104:107], v[176:179], v[136:139]
  ds_read_b128 v[172:175], v2 offset:28672
  s_waitcnt lgkmcnt(7)
  v_mfma_f32_16x16x32_bf16 v[140:143], v[104:107], v[180:183], v[140:143]
  ds_read_b128 v[176:179], v2 offset:29696
  s_waitcnt lgkmcnt(7)
  v_mfma_f32_16x16x32_bf16 v[128:131], v[184:187], v[108:111], v[128:131]
  ds_read_b128 v[180:183], v2 offset:32768
  s_waitcnt lgkmcnt(7)
  v_mfma_f32_16x16x32_bf16 v[132:135], v[152:155], v[108:111], v[132:135]
  ds_read_b128 v[184:187], v2 offset:33792
  s_waitcnt lgkmcnt(7)
  v_mfma_f32_16x16x32_bf16 v[136:139], v[108:111], v[156:159], v[136:139]
  ds_read_b128 v[152:155], v2 offset:34816
  s_waitcnt lgkmcnt(7)
  v_mfma_f32_16x16x32_bf16 v[140:143], v[108:111], v[160:163], v[140:143]
  ds_read_b128 v[156:159], v2 offset:35840
  s_waitcnt vmcnt(4)
  s_mov_b32 s56, 0
L_chk_10:
  v_max3_u32 v255, v112, v113, v114
  v_max3_u32 v255, v255, v115, v116
  v_max3_u32 v255, v255, v117, v118
  v_max3_u32 v255, v255, v119, v120
  v_max3_u32 v255, v255, v121, v122
  v_max3_u32 v255, v255, v123, v124
  v_max3_u32 v255, v255, v125, v126
  v_max_u32 v255, v255, v127
  v_cmp_eq_u32 vcc, -1, v255
  s_cbranch_vccnz L_rt_11
L_cd_12:
  s_mov_b32 s56, 0
L_chk_13:
  v_max3_u32 v255, v224, v225, v226
  v_max3_u32 v255, v255, v227, v228
  v_max3_u32 v255, v255, v229, v230
  v_max_u32 v255, v255, v231
  v_cmp_eq_u32 vcc, -1, v255
  s_cbranch_vccnz L_rt_14
L_cd_15:
  v_add_f32 v224, v224, v226
  v_add_f32 v225, v225, v227
  v_add_f32 v228, v228, v230
  v_add_f32 v229, v229, v231
  v_add_f32 v224, v224, v228
  v_add_f32 v225, v225, v229
  s_nop 0
  v_mfma_f32_16x16x4_f32 v[216:219], v6, v224, 0
  v_mfma_f32_16x16x4_f32 v[220:223], v6, v225, 0
  s_nop 8
  v_mul_f32 v216, 0x3b000000, v216
  v_mul_f32 v220, 0x3b000000, v220
  v_fma_f32 v220, -v216, v216, v220
  v_max_f32 v220, 0, v220
  v_cvt_pk_bf16_f32 v217, v216, v220
  v_lshlrev_b32 v252, 16, v217
  v_and_b32 v220, 0xffff0000, v217
  v_add_f32 v220, 0x3727c5ac, v220
  v_cvt_pk_bf16_f32 v220, v220, v220
  v_lshlrev_b32 v220, 16, v220
  v_sqrt_f32 v220, v220
  s_nop 0
  v_cvt_pk_bf16_f32 v220, v220, v220
  v_lshlrev_b32 v220, 16, v220
  v_rcp_f32 v253, v220
  ds_bpermute_b32 v236, v246, v252 offset:0
  ds_bpermute_b32 v240, v246, v253 offset:0
  ds_bpermute_b32 v237, v246, v252 offset:4
  ds_bpermute_b32 v241, v246, v253 offset:4
  ds_bpermute_b32 v238, v246, v252 offset:8
  ds_bpermute_b32 v242, v246, v253 offset:8
  ds_bpermute_b32 v239, v246, v252 offset:12
  ds_bpermute_b32 v243, v246, v253 offset:12
  s_waitcnt lgkmcnt(7)
  v_mfma_f32_16x16x32_bf16 v[128:131], v[164:167], v[112:115], v[128:131]
  ds_read_b128 v[160:163], v2 offset:38912
  s_waitcnt lgkmcnt(7)
  v_mfma_f32_16x16x32_bf16 v[132:135], v[168:171], v[112:115], v[132:135]
  ds_read_b128 v[164:167], v2 offset:39936
  s_waitcnt lgkmcnt(7)
  v_mfma_f32_16x16x32_bf16 v[136:139], v[112:115], v[172:175], v[136:139]
  ds_read_b128 v[168:171], v2 offset:40960
  s_waitcnt lgkmcnt(7)
  v_mfma_f32_16x16x32_bf16 v[140:143], v[112:115], v[176:179], v[140:143]
  ds_read_b128 v[172:175], v2 offset:41984
  s_waitcnt lgkmcnt(7)
  v_mfma_f32_16x16x32_bf16 v[128:131], v[180:183], v[116:119], v[128:131]
  ds_read_b128 v[176:179], v2 offset:45056
  s_waitcnt lgkmcnt(7)
  v_mfma_f32_16x16x32_bf16 v[132:135], v[184:187], v[116:119], v[132:135]
  ds_read_b128 v[180:183], v2 offset:46080
  s_waitcnt lgkmcnt(7)
  v_mfma_f32_16x16x32_bf16 v[136:139], v[116:119], v[152:155], v[136:139]
  ds_read_b128 v[184:187], v2 offset:47104
  s_waitcnt lgkmcnt(7)
  v_mfma_f32_16x16x32_bf16 v[140:143], v[116:119], v[156:159], v[140:143]
  ds_read_b128 v[152:155], v2 offset:48128
  s_waitcnt lgkmcnt(7)
  v_mfma_f32_16x16x32_bf16 v[128:131], v[160:163], v[120:123], v[128:131]
  s_waitcnt lgkmcnt(6)
  v_mfma_f32_16x16x32_bf16 v[132:135], v[164:167], v[120:123], v[132:135]
  s_waitcnt lgkmcnt(5)
  v_mfma_f32_16x16x32_bf16 v[136:139], v[120:123], v[168:171], v[136:139]
  s_waitcnt lgkmcnt(4)
  v_mfma_f32_16x16x32_bf16 v[140:143], v[120:123], v[172:175], v[140:143]
  s_waitcnt lgkmcnt(3)
  v_mfma_f32_16x16x32_bf16 v[128:131], v[176:179], v[124:127], v[128:131]
  s_waitcnt lgkmcnt(2)
  v_mfma_f32_16x16x32_bf16 v[132:135], v[180:183], v[124:127], v[132:135]
  s_waitcnt lgkmcnt(1)
  v_mfma_f32_16x16x32_bf16 v[136:139], v[124:127], v[184:187], v[136:139]
  s_waitcnt lgkmcnt(0)
  v_mfma_f32_16x16x32_bf16 v[140:143], v[124:127], v[152:155], v[140:143]
  s_mul_i32 s53, s32, 12288
  s_add_u32 s52, s67, s53
  buffer_load_dword v233, v15, s[4:7], s52 offen
  s_add_u32 s52, s52, 4096
  buffer_load_dword v233, v15, s[4:7], s52 offen
  v_fma_f32 v128, -v252, v24, v128
  v_fma_f32 v132, -v252, v28, v132
  v_fma_f32 v129, -v252, v25, v129
  v_fma_f32 v133, -v252, v29, v133
  v_fma_f32 v130, -v252, v26, v130
  v_fma_f32 v134, -v252, v30, v134
  v_fma_f32 v131, -v252, v27, v131
  v_fma_f32 v135, -v252, v31, v135
  v_mul_f32 v128, v128, v253
  v_mul_f32 v132, v132, v253
  v_mul_f32 v129, v129, v253
  v_mul_f32 v133, v133, v253
  v_mul_f32 v130, v130, v253
  v_mul_f32 v134, v134, v253
  v_mul_f32 v131, v131, v253
  v_mul_f32 v135, v135, v253
  v_cvt_pk_bf16_f32 v156, v128, v129
  v_cvt_pk_bf16_f32 v180, v132, v133
  v_cvt_pk_bf16_f32 v157, v130, v131
  v_cvt_pk_bf16_f32 v181, v134, v135
  s_nop 0
  v_mfma_f32_16x16x16_bf16 v[152:155], v[10:11], v[156:157], 0
  v_mfma_f32_16x16x16_bf16 v[176:179], v[12:13], v[180:181], 0
  s_waitcnt lgkmcnt(0)
  v_fma_f32 v136, -v236, v32, v136
  v_fma_f32 v140, -v236, v33, v140
  v_fma_f32 v137, -v237, v32, v137
  v_fma_f32 v141, -v237, v33, v141
  v_fma_f32 v138, -v238, v32, v138
  v_fma_f32 v142, -v238, v33, v142
  v_fma_f32 v139, -v239, v32, v139
  v_fma_f32 v143, -v239, v33, v143
  v_mul_f32 v136, v136, v240
  v_mul_f32 v140, v140, v240
  v_mul_f32 v137, v137, v241
  v_mul_f32 v141, v141, v241
  v_mul_f32 v138, v138, v242
  v_mul_f32 v142, v142, v242
  v_mul_f32 v139, v139, v243
  v_mul_f32 v143, v143, v243
  v_cvt_pk_bf16_f32 v216, v136, v137
  v_cvt_pk_bf16_f32 v218, v140, v141
  v_cvt_pk_bf16_f32 v217, v138, v139
  v_cvt_pk_bf16_f32 v219, v142, v143
  v_cvt_pk_bf16_f32 v156, v152, v153
  v_cvt_pk_bf16_f32 v180, v176, v177
  v_cvt_pk_bf16_f32 v157, v154, v155
  v_cvt_pk_bf16_f32 v181, v178, v179
  v_lshlrev_b32 v152, 16, v156
  v_lshlrev_b32 v176, 16, v180
  v_and_b32 v153, 0xffff0000, v156
  v_and_b32 v177, 0xffff0000, v180
  v_lshlrev_b32 v154, 16, v157
  v_lshlrev_b32 v178, 16, v181
  v_and_b32 v155, 0xffff0000, v157
  v_and_b32 v179, 0xffff0000, v181
  v_max_f32 v158, v152, v153
  v_max_f32 v182, v176, v177
  v_min_f32 v159, v152, v153
  v_min_f32 v183, v176, v177
  v_max_f32 v160, v154, v155
  v_max_f32 v184, v178, v179
  v_min_f32 v161, v154, v155
  v_min_f32 v185, v178, v179
  v_max_f32 v158, v158, v160
  v_max_f32 v182, v182, v184
  v_min_f32 v159, v159, v161
  v_min_f32 v183, v183, v185
  ds_swizzle_b32 v160, v158 offset:0x401f
  ds_swizzle_b32 v184, v182 offset:0x401f
  ds_bpermute_b32 v161, v244, v158
  ds_bpermute_b32 v185, v244, v182
  ds_bpermute_b32 v162, v245, v158
  ds_bpermute_b32 v186, v245, v182
  ds_swizzle_b32 v163, v159 offset:0x401f
  ds_swizzle_b32 v187, v183 offset:0x401f
  ds_bpermute_b32 v164, v244, v159
  ds_bpermute_b32 v188, v244, v183
  ds_bpermute_b32 v165, v245, v159
  ds_bpermute_b32 v189, v245, v183
  s_waitcnt lgkmcnt(0)
  v_max_f32 v158, v158, v160
  v_max_f32 v182, v182, v184
  v_min_f32 v159, v159, v163
  v_min_f32 v183, v183, v187
  v_max_f32 v161, v161, v162
  v_max_f32 v185, v185, v186
  v_min_f32 v164, v164, v165
  v_min_f32 v188, v188, v189
  v_max_f32 v158, v158, v161
  v_max_f32 v182, v182, v185
  v_min_f32 v159, v159, v164
  v_min_f32 v183, v183, v188
  v_mul_f32 v158, s60, v158
  v_mul_f32 v182, s60, v182
  v_mul_f32 v159, s60, v159
  v_mul_f32 v183, s60, v183
  v_fma_f32 v166, v152, s60, -v158
  v_fma_f32 v190, v176, s60, -v182
  v_fma_f32 v170, -v152, s60, v159
  v_fma_f32 v194, -v176, s60, v183
  v_fma_f32 v167, v153, s60, -v158
  v_fma_f32 v191, v177, s60, -v182
  v_fma_f32 v171, -v153, s60, v159
  v_fma_f32 v195, -v177, s60, v183
  v_fma_f32 v168, v154, s60, -v158
  v_fma_f32 v192, v178, s60, -v182
  v_fma_f32 v172, -v154, s60, v159
  v_fma_f32 v196, -v178, s60, v183
  v_fma_f32 v169, v155, s60, -v158
  v_fma_f32 v193, v179, s60, -v182
  v_fma_f32 v173, -v155, s60, v159
  v_fma_f32 v197, -v179, s60, v183
  v_exp_f32 v166, v166
  v_exp_f32 v190, v190
  v_exp_f32 v167, v167
  v_exp_f32 v191, v191
  v_exp_f32 v168, v168
  v_exp_f32 v192, v192
  v_exp_f32 v169, v169
  v_exp_f32 v193, v193
  v_exp_f32 v170, v170
  v_exp_f32 v194, v194
  v_exp_f32 v171, v171
  v_exp_f32 v195, v195
  v_exp_f32 v172, v172
  v_exp_f32 v196, v196
  v_exp_f32 v173, v173
  v_exp_f32 v197, v197
  v_add_f32 v156, v166, v167
  v_add_f32 v180, v190, v191
  v_add_f32 v157, v170, v171
  v_add_f32 v181, v194, v195
  v_add_f32 v158, v168, v169
  v_add_f32 v182, v192, v193
  v_add_f32 v159, v172, v173
  v_add_f32 v183, v196, v197
  v_add_f32 v156, v156, v158
  v_add_f32 v180, v180, v182
  v_add_f32 v157, v157, v159
  v_add_f32 v181, v181, v183
  v_mfma_f32_16x16x4_f32 v[152:155], v6, v156, 0
  v_mfma_f32_16x16x4_f32 v[176:179], v6, v180, 0
  v_mfma_f32_16x16x4_f32 v[160:163], v6, v157, 0
  v_mfma_f32_16x16x4_f32 v[184:187], v6, v181, 0
  s_nop 6
  v_rcp_f32 v152, v152
  v_rcp_f32 v176, v176
  v_rcp_f32 v160, v160
  v_rcp_f32 v184, v184
  v_mul_f32 v166, v166, v152
  v_mul_f32 v190, v190, v176
  v_mul_f32 v170, v170, v160
  v_mul_f32 v194, v194, v184
  v_mul_f32 v167, v167, v152
  v_mul_f32 v191, v191, v176
  v_mul_f32 v171, v171, v160
  v_mul_f32 v195, v195, v184
  v_mul_f32 v168, v168, v152
  v_mul_f32 v192, v192, v176
  v_mul_f32 v172, v172, v160
  v_mul_f32 v196, v196, v184
  v_mul_f32 v169, v169, v152
  v_mul_f32 v193, v193, v176
  v_mul_f32 v173, v173, v160
  v_mul_f32 v197, v197, v184
  v_cvt_pk_bf16_f32 v200, v166, v167
  v_cvt_pk_bf16_f32 v204, v190, v191
  v_cvt_pk_bf16_f32 v201, v168, v169
  v_cvt_pk_bf16_f32 v205, v192, v193
  v_cvt_pk_bf16_f32 v202, v170, v171
  v_cvt_pk_bf16_f32 v206, v194, v195
  v_cvt_pk_bf16_f32 v203, v172, v173
  v_cvt_pk_bf16_f32 v207, v196, v197
  v_mfma_f32_16x16x16_bf16 v[152:155], v[200:201], v[8:9], 0
  v_mfma_f32_16x16x16_bf16 v[156:159], v[202:203], v[8:9], 0
  v_mfma_f32_16x16x16_bf16 v[160:163], v[204:205], v[8:9], 0
  v_mfma_f32_16x16x16_bf16 v[164:167], v[206:207], v[8:9], 0
  s_mul_i32 s53, s32, 3072
  v_add_u32 v255, s53, v234
  ds_write_b128 v255, v[216:219] offset:2048
  s_nop 1
  v_cvt_pk_bf16_f32 v208, v152, v153
  v_cvt_pk_bf16_f32 v209, v154, v155
  v_cvt_pk_bf16_f32 v210, v156, v157
  v_cvt_pk_bf16_f32 v211, v158, v159
  v_cvt_pk_bf16_f32 v212, v160, v161
  v_cvt_pk_bf16_f32 v213, v162, v163
  v_cvt_pk_bf16_f32 v214, v164, v165
  v_cvt_pk_bf16_f32 v215, v166, v167
  ds_write_b128 v255, v[208:211]
  ds_write_b128 v255, v[212:215] offset:1024
  s_waitcnt lgkmcnt(0)
  s_barrier
  s_cmp_ge_u32 s32, 4
  s_cbranch_scc1 L_A_noatom
  s_lshr_b32 s53, s32, 1
  s_and_b32 s54, s32, 1
  s_lshl_b32 s55, s53, 10
  s_lshl_b32 s57, s54, 3
  s_add_u32 s55, s55, s57
  v_add_u32 v200, s55, v234
  s_lshl_b32 s55, s53, 3
  s_add_u32 s55, s55, 2048
  v_add_u32 v201, s55, v234
  ds_read_b64 v[152:153], v200 offset:0
  ds_read_b64 v[168:169], v201 offset:0
  ds_read_b64 v[154:155], v200 offset:3072
  ds_read_b64 v[170:171], v201 offset:3072
  ds_read_b64 v[156:157], v200 offset:6144
  ds_read_b64 v[172:173], v201 offset:6144
  ds_read_b64 v[158:159], v200 offset:9216
  ds_read_b64 v[174:175], v201 offset:9216
  ds_read_b64 v[160:161], v200 offset:12288
  ds_read_b64 v[176:177], v201 offset:12288
  ds_read_b64 v[162:163], v200 offset:15360
  ds_read_b64 v[178:179], v201 offset:15360
  ds_read_b64 v[164:165], v200 offset:18432
  ds_read_b64 v[180:181], v201 offset:18432
  ds_read_b64 v[166:167], v200 offset:21504
  ds_read_b64 v[182:183], v201 offset:21504
  s_lshl_b32 s57, s32, 14
  s_lshl_b32 s55, s30, 10
  s_add_u32 s57, s57, s55
  s_add_u32 s57, s57, s51
  s_lshl_b32 s58, s32, 6
  s_lshl_b32 s55, s30, 8
  s_add_u32 s58, s58, s55
  s_add_u32 s58, s58, s50
  s_waitcnt lgkmcnt(12)
  v_mfma_f32_16x16x32_bf16 v[184:187], v[152:155], v[168:171], 0
  v_mfma_f32_16x16x32_bf16 v[188:191], v[152:155], v[248:251], 0
  s_waitcnt lgkmcnt(8)
  v_mfma_f32_16x16x32_bf16 v[184:187], v[156:159], v[172:175], v[184:187]
  v_mfma_f32_16x16x32_bf16 v[188:191], v[156:159], v[248:251], v[188:191]
  s_waitcnt lgkmcnt(4)
  v_mfma_f32_16x16x32_bf16 v[184:187], v[160:163], v[176:179], v[184:187]
  v_mfma_f32_16x16x32_bf16 v[188:191], v[160:163], v[248:251], v[188:191]
  s_waitcnt lgkmcnt(0)
  v_mfma_f32_16x16x32_bf16 v[184:187], v[164:167], v[180:183], v[184:187]
  v_mfma_f32_16x16x32_bf16 v[188:191], v[164:167], v[248:251], v[188:191]
  s_nop 6
  buffer_store_dwordx4 v[184:187], v1, s[4:7], s57 offen sc1
  s_mov_b32 s54, 0x00010001
  s_mov_b32 s55, 0x00010001
  s_mov_b64 exec, s[54:55]
  buffer_store_dwordx4 v[188:191], v246, s[4:7], s58 offen sc1
  s_mov_b64 exec, -1
  s_nop 15
  s_nop 3
L_A_noatom:
  s_mov_b64 exec, 0xffff
  buffer_load_dword v254, v14, s[4:7], s75 offen sc1
  s_mov_b64 exec, -1
  ds_read_b128 v[152:155], v1 offset:0
  ds_read_b128 v[156:159], v1 offset:1024
  ds_read_b128 v[160:163], v1 offset:6144
  ds_read_b128 v[164:167], v1 offset:7168
  ds_read_b128 v[168:171], v1 offset:12288
  ds_read_b128 v[172:175], v1 offset:13312
  ds_read_b128 v[176:179], v1 offset:18432
  ds_read_b128 v[180:183], v1 offset:19456
  s_waitcnt lgkmcnt(7)
  v_mfma_f32_16x16x32_bf16 v[144:147], v[152:155], v[64:67], 0
  ds_read_b128 v[184:187], v1 offset:24576
  s_waitcnt lgkmcnt(7)
  v_mfma_f32_16x16x32_bf16 v[148:151], v[156:159], v[64:67], 0
  ds_read_b128 v[152:155], v1 offset:25600
  s_waitcnt lgkmcnt(7)
  v_mfma_f32_16x16x32_bf16 v[144:147], v[160:163], v[68:71], v[144:147]
  ds_read_b128 v[156:159], v1 offset:30720
  s_waitcnt lgkmcnt(7)
  v_mfma_f32_16x16x32_bf16 v[148:151], v[164:167], v[68:71], v[148:151]
  ds_read_b128 v[160:163], v1 offset:31744
  s_waitcnt lgkmcnt(7)
  v_mfma_f32_16x16x32_bf16 v[144:147], v[168:171], v[72:75], v[144:147]
  ds_read_b128 v[164:167], v1 offset:36864
  s_waitcnt lgkmcnt(7)
  v_mfma_f32_16x16x32_bf16 v[148:151], v[172:175], v[72:75], v[148:151]
  ds_read_b128 v[168:171], v1 offset:37888
  s_waitcnt lgkmcnt(7)
  v_mfma_f32_16x16x32_bf16 v[144:147], v[176:179], v[76:79], v[144:147]
  ds_read_b128 v[172:175], v1 offset:43008
  s_waitcnt lgkmcnt(7)
  v_mfma_f32_16x16x32_bf16 v[148:151], v[180:183], v[76:79], v[148:151]
  ds_read_b128 v[176:179], v1 offset:44032
  s_waitcnt lgkmcnt(7)
  v_mfma_f32_16x16x32_bf16 v[144:147], v[184:187], v[80:83], v[144:147]
  ds_read_b128 v[180:183], v2 offset:0
  s_waitcnt lgkmcnt(7)
  v_mfma_f32_16x16x32_bf16 v[148:151], v[152:155], v[80:83], v[148:151]
  ds_read_b128 v[184:187], v2 offset:1024
  s_waitcnt lgkmcnt(7)
  v_mfma_f32_16x16x32_bf16 v[144:147], v[156:159], v[84:87], v[144:147]
  ds_read_b128 v[152:155], v2 offset:6144
  s_waitcnt lgkmcnt(7)
  v_mfma_f32_16x16x32_bf16 v[148:151], v[160:163], v[84:87], v[148:151]
  ds_read_b128 v[156:159], v2 offset:7168
  s_waitcnt lgkmcnt(7)
  v_mfma_f32_16x16x32_bf16 v[144:147], v[164:167], v[88:91], v[144:147]
  ds_read_b128 v[160:163], v2 offset:12288
  s_waitcnt lgkmcnt(7)
  v_mfma_f32_16x16x32_bf16 v[148:151], v[168:171], v[88:91], v[148:151]
  ds_read_b128 v[164:167], v2 offset:13312
  s_waitcnt lgkmcnt(7)
  v_mfma_f32_16x16x32_bf16 v[144:147], v[172:175], v[92:95], v[144:147]
  ds_read_b128 v[168:171], v2 offset:18432
  s_waitcnt lgkmcnt(7)
  v_mfma_f32_16x16x32_bf16 v[148:151], v[176:179], v[92:95], v[148:151]
  ds_read_b128 v[172:175], v2 offset:19456
  s_waitcnt lgkmcnt(7)
  v_mfma_f32_16x16x32_bf16 v[144:147], v[180:183], v[96:99], v[144:147]
  ds_read_b128 v[176:179], v2 offset:24576
  s_waitcnt lgkmcnt(7)
  v_mfma_f32_16x16x32_bf16 v[148:151], v[184:187], v[96:99], v[148:151]
  ds_read_b128 v[180:183], v2 offset:25600
  s_waitcnt lgkmcnt(7)
  v_mfma_f32_16x16x32_bf16 v[144:147], v[152:155], v[100:103], v[144:147]
  ds_read_b128 v[184:187], v2 offset:30720
  s_waitcnt lgkmcnt(7)
  v_mfma_f32_16x16x32_bf16 v[148:151], v[156:159], v[100:103], v[148:151]
  ds_read_b128 v[152:155], v2 offset:31744
  s_waitcnt lgkmcnt(7)
  v_mfma_f32_16x16x32_bf16 v[144:147], v[160:163], v[104:107], v[144:147]
  ds_read_b128 v[156:159], v2 offset:36864
  s_waitcnt lgkmcnt(7)
  v_mfma_f32_16x16x32_bf16 v[148:151], v[164:167], v[104:107], v[148:151]
  ds_read_b128 v[160:163], v2 offset:37888
  s_waitcnt lgkmcnt(7)
  v_mfma_f32_16x16x32_bf16 v[144:147], v[168:171], v[108:111], v[144:147]
  ds_read_b128 v[164:167], v2 offset:43008
  s_waitcnt lgkmcnt(7)
  v_mfma_f32_16x16x32_bf16 v[148:151], v[172:175], v[108:111], v[148:151]
  ds_read_b128 v[168:171], v2 offset:44032
  s_waitcnt lgkmcnt(7)
  v_mfma_f32_16x16x32_bf16 v[144:147], v[176:179], v[112:115], v[144:147]
  s_waitcnt lgkmcnt(6)
  v_mfma_f32_16x16x32_bf16 v[148:151], v[180:183], v[112:115], v[148:151]
  s_waitcnt lgkmcnt(5)
  v_mfma_f32_16x16x32_bf16 v[144:147], v[184:187], v[116:119], v[144:147]
  s_waitcnt lgkmcnt(4)
  v_mfma_f32_16x16x32_bf16 v[148:151], v[152:155], v[116:119], v[148:151]
  s_waitcnt lgkmcnt(3)
  v_mfma_f32_16x16x32_bf16 v[144:147], v[156:159], v[120:123], v[144:147]
  s_waitcnt lgkmcnt(2)
  v_mfma_f32_16x16x32_bf16 v[148:151], v[160:163], v[120:123], v[148:151]
  s_waitcnt lgkmcnt(1)
  v_mfma_f32_16x16x32_bf16 v[144:147], v[164:167], v[124:127], v[144:147]
  s_waitcnt lgkmcnt(0)
  v_mfma_f32_16x16x32_bf16 v[148:151], v[168:171], v[124:127], v[148:151]
  s_barrier
  s_mul_i32 s53, s32, 12288
  s_add_u32 s52, s67, s53
  s_lshl_b32 s57, s32, 13
  s_add_u32 s57, s57, s51
  s_add_u32 s58, s57, 4096
  buffer_load_dwordx4 v[64:67], v1, s[4:7], s57 offen offset:0 sc1
  buffer_load_dwordx4 v[68:71], v1, s[4:7], s57 offen offset:1024 sc1
  buffer_load_dwordx4 v[72:75], v1, s[4:7], s57 offen offset:2048 sc1
  buffer_load_dwordx4 v[76:79], v1, s[4:7], s57 offen offset:3072 sc1
  buffer_load_dwordx4 v[80:83], v1, s[4:7], s58 offen offset:0 sc1
  buffer_load_dwordx4 v[84:87], v1, s[4:7], s58 offen offset:1024 sc1
  buffer_load_dwordx4 v[88:91], v1, s[4:7], s58 offen offset:2048 sc1
  buffer_load_dwordx4 v[92:95], v1, s[4:7], s58 offen offset:3072 sc1
  s_cmp_lg_u32 s32, 7
  s_cbranch_scc1 L_A_noz0
  buffer_load_dwordx4 v[96:99], v1, s[4:7], s50 offen offset:0 sc1
  buffer_load_dwordx4 v[100:103], v1, s[4:7], s50 offen offset:1024 sc1
  buffer_load_dwordx4 v[104:107], v1, s[4:7], s50 offen offset:2048 sc1
  buffer_load_dwordx4 v[108:111], v1, s[4:7], s50 offen offset:3072 sc1
L_A_noz0:
  v_fma_f32 v144, -v252, v16, v144
  v_fma_f32 v148, -v252, v20, v148
  v_fma_f32 v145, -v252, v17, v145
  v_fma_f32 v149, -v252, v21, v149
  v_fma_f32 v146, -v252, v18, v146
  v_fma_f32 v150, -v252, v22, v150
  v_fma_f32 v147, -v252, v19, v147
  v_fma_f32 v151, -v252, v23, v151
  v_mul_f32 v144, v144, v253
  v_mul_f32 v148, v148, v253
  v_mul_f32 v145, v145, v253
  v_mul_f32 v149, v149, v253
  v_mul_f32 v146, v146, v253
  v_mul_f32 v150, v150, v253
  v_mul_f32 v147, v147, v253
  v_mul_f32 v151, v151, v253
  v_cvt_pk_bf16_f32 v156, v144, v145
  v_cvt_pk_bf16_f32 v180, v148, v149
  v_cvt_pk_bf16_f32 v157, v146, v147
  v_cvt_pk_bf16_f32 v181, v150, v151
  s_nop 0
  v_mfma_f32_16x16x16_bf16 v[152:155], v[10:11], v[156:157], 0
  v_mfma_f32_16x16x16_bf16 v[176:179], v[12:13], v[180:181], 0
  s_nop 6
  v_cvt_pk_bf16_f32 v156, v152, v153
  v_cvt_pk_bf16_f32 v180, v176, v177
  v_cvt_pk_bf16_f32 v157, v154, v155
  v_cvt_pk_bf16_f32 v181, v178, v179
  v_lshlrev_b32 v152, 16, v156
  v_lshlrev_b32 v176, 16, v180
  v_and_b32 v153, 0xffff0000, v156
  v_and_b32 v177, 0xffff0000, v180
  v_lshlrev_b32 v154, 16, v157
  v_lshlrev_b32 v178, 16, v181
  v_and_b32 v155, 0xffff0000, v157
  v_and_b32 v179, 0xffff0000, v181
  v_max_f32 v158, v152, v153
  v_max_f32 v182, v176, v177
  v_min_f32 v159, v152, v153
  v_min_f32 v183, v176, v177
  v_max_f32 v160, v154, v155
  v_max_f32 v184, v178, v179
  v_min_f32 v161, v154, v155
  v_min_f32 v185, v178, v179
  v_max_f32 v158, v158, v160
  v_max_f32 v182, v182, v184
  v_min_f32 v159, v159, v161
  v_min_f32 v183, v183, v185
  ds_swizzle_b32 v160, v158 offset:0x401f
  ds_swizzle_b32 v184, v182 offset:0x401f
  ds_bpermute_b32 v161, v244, v158
  ds_bpermute_b32 v185, v244, v182
  ds_bpermute_b32 v162, v245, v158
  ds_bpermute_b32 v186, v245, v182
  ds_swizzle_b32 v163, v159 offset:0x401f
  ds_swizzle_b32 v187, v183 offset:0x401f
  ds_bpermute_b32 v164, v244, v159
  ds_bpermute_b32 v188, v244, v183
  ds_bpermute_b32 v165, v245, v159
  ds_bpermute_b32 v189, v245, v183
  s_waitcnt lgkmcnt(0)
  v_max_f32 v158, v158, v160
  v_max_f32 v182, v182, v184
  v_min_f32 v159, v159, v163
  v_min_f32 v183, v183, v187
  v_max_f32 v161, v161, v162
  v_max_f32 v185, v185, v186
  v_min_f32 v164, v164, v165
  v_min_f32 v188, v188, v189
  v_max_f32 v158, v158, v161
  v_max_f32 v182, v182, v185
  v_min_f32 v159, v159, v164
  v_min_f32 v183, v183, v188
  v_mul_f32 v158, s60, v158
  v_mul_f32 v182, s60, v182
  v_mul_f32 v159, s60, v159
  v_mul_f32 v183, s60, v183
  v_fma_f32 v166, v152, s60, -v158
  v_fma_f32 v190, v176, s60, -v182
  v_fma_f32 v170, -v152, s60, v159
  v_fma_f32 v194, -v176, s60, v183
  v_fma_f32 v167, v153, s60, -v158
  v_fma_f32 v191, v177, s60, -v182
  v_fma_f32 v171, -v153, s60, v159
  v_fma_f32 v195, -v177, s60, v183
  v_fma_f32 v168, v154, s60, -v158
  v_fma_f32 v192, v178, s60, -v182
  v_fma_f32 v172, -v154, s60, v159
  v_fma_f32 v196, -v178, s60, v183
  v_fma_f32 v169, v155, s60, -v158
  v_fma_f32 v193, v179, s60, -v182
  v_fma_f32 v173, -v155, s60, v159
  v_fma_f32 v197, -v179, s60, v183
  v_exp_f32 v166, v166
  v_exp_f32 v190, v190
  v_exp_f32 v167, v167
  v_exp_f32 v191, v191
  v_exp_f32 v168, v168
  v_exp_f32 v192, v192
  v_exp_f32 v169, v169
  v_exp_f32 v193, v193
  v_exp_f32 v170, v170
  v_exp_f32 v194, v194
  v_exp_f32 v171, v171
  v_exp_f32 v195, v195
  v_exp_f32 v172, v172
  v_exp_f32 v196, v196
  v_exp_f32 v173, v173
  v_exp_f32 v197, v197
  v_add_f32 v156, v166, v167
  v_add_f32 v180, v190, v191
  v_add_f32 v157, v170, v171
  v_add_f32 v181, v194, v195
  v_add_f32 v158, v168, v169
  v_add_f32 v182, v192, v193
  v_add_f32 v159, v172, v173
  v_add_f32 v183, v196, v197
  v_add_f32 v156, v156, v158
  v_add_f32 v180, v180, v182
  v_add_f32 v157, v157, v159
  v_add_f32 v181, v181, v183
  v_mfma_f32_16x16x4_f32 v[152:155], v6, v156, 0
  v_mfma_f32_16x16x4_f32 v[176:179], v6, v180, 0
  v_mfma_f32_16x16x4_f32 v[160:163], v6, v157, 0
  v_mfma_f32_16x16x4_f32 v[184:187], v6, v181, 0
  s_nop 6
  v_rcp_f32 v152, v152
  v_rcp_f32 v176, v176
  v_rcp_f32 v160, v160
  v_rcp_f32 v184, v184
  v_mul_f32 v166, v166, v152
  v_mul_f32 v190, v190, v176
  v_mul_f32 v170, v170, v160
  v_mul_f32 v194, v194, v184
  v_mul_f32 v167, v167, v152
  v_mul_f32 v191, v191, v176
  v_mul_f32 v171, v171, v160
  v_mul_f32 v195, v195, v184
  v_mul_f32 v168, v168, v152
  v_mul_f32 v192, v192, v176
  v_mul_f32 v172, v172, v160
  v_mul_f32 v196, v196, v184
  v_mul_f32 v169, v169, v152
  v_mul_f32 v193, v193, v176
  v_mul_f32 v173, v173, v160
  v_mul_f32 v197, v197, v184
  v_cvt_pk_bf16_f32 v200, v166, v167
  v_cvt_pk_bf16_f32 v204, v190, v191
  v_cvt_pk_bf16_f32 v201, v168, v169
  v_cvt_pk_bf16_f32 v205, v192, v193
  v_cvt_pk_bf16_f32 v202, v170, v171
  v_cvt_pk_bf16_f32 v206, v194, v195
  v_cvt_pk_bf16_f32 v203, v172, v173
  v_cvt_pk_bf16_f32 v207, v196, v197
  s_waitcnt vmcnt(0)
  s_cmp_lg_u32 s39, 0
  s_cbranch_scc1 L_nodec
  s_mov_b32 s56, 0
  s_mov_b64 exec, 0xffff
L_xid:
  v_cmp_eq_u32 vcc, 0, v254
  s_cbranch_vccz L_xid_done
  s_add_u32 s56, s56, 1
  s_cmp_gt_u32 s56, 0x40000
  s_cbranch_scc1 L_xid_done
  buffer_load_dword v254, v14, s[4:7], s75 offen sc1
  s_waitcnt vmcnt(0)
  s_branch L_xid
L_xid_done:
  v_cmp_ne_u32 vcc, s74, v254
  s_mov_b64 exec, -1
  s_cmp_eq_u64 vcc, 0
  s_cselect_b32 s73, 1, 0
L_nodec:
  s_mov_b32 s56, 0
L_chk_16:
  v_max3_u32 v255, v64, v65, v66
  v_max3_u32 v255, v255, v67, v68
  v_max3_u32 v255, v255, v69, v70
  v_max3_u32 v255, v255, v71, v72
  v_max3_u32 v255, v255, v73, v74
  v_max3_u32 v255, v255, v75, v76
  v_max3_u32 v255, v255, v77, v78
  v_max3_u32 v255, v255, v79, v80
  v_max3_u32 v255, v255, v81, v82
  v_max3_u32 v255, v255, v83, v84
  v_max3_u32 v255, v255, v85, v86
  v_max3_u32 v255, v255, v87, v88
  v_max3_u32 v255, v255, v89, v90
  v_max3_u32 v255, v255, v91, v92
  v_max3_u32 v255, v255, v93, v94
  v_max_u32 v255, v255, v95
  v_cmp_eq_u32 vcc, -1, v255
  s_cbranch_vccnz L_rt_17
L_cd_18:
  v_add_f32 v64, v64, v80
  v_add_f32 v65, v65, v81
  v_add_f32 v66, v66, v82
  v_add_f32 v67, v67, v83
  v_add_f32 v68, v68, v84
  v_add_f32 v69, v69, v85
  v_add_f32 v70, v70, v86
  v_add_f32 v71, v71, v87
  v_add_f32 v72, v72, v88
  v_add_f32 v73, v73, v89
  v_add_f32 v74, v74, v90
  v_add_f32 v75, v75, v91
  v_add_f32 v76, v76, v92
  v_add_f32 v77, v77, v93
  v_add_f32 v78, v78, v94
  v_add_f32 v79, v79, v95
  v_add_f32 v64, v64, v72
  v_add_f32 v65, v65, v73
  v_add_f32 v66, v66, v74
  v_add_f32 v67, v67, v75
  v_add_f32 v68, v68, v76
  v_add_f32 v69, v69, v77
  v_add_f32 v70, v70, v78
  v_add_f32 v71, v71, v79
  v_add_f32 v64, v64, v68
  v_add_f32 v65, v65, v69
  v_add_f32 v66, v66, v70
  v_add_f32 v67, v67, v71
  s_lshl_b32 s53, s32, 10
  v_add_u32 v255, s53, v234
  ds_write_b128 v255, v[64:67]
  s_cmp_lg_u32 s32, 7
  s_cbranch_scc1 L_A_noz2
  s_mov_b32 s56, 0
L_chk_19:
  v_max3_u32 v255, v96, v97, v98
  v_max3_u32 v255, v255, v99, v100
  v_max3_u32 v255, v255, v101, v102
  v_max3_u32 v255, v255, v103, v104
  v_max3_u32 v255, v255, v105, v106
  v_max3_u32 v255, v255, v107, v108
  v_max3_u32 v255, v255, v109, v110
  v_max_u32 v255, v255, v111
  v_cmp_eq_u32 vcc, -1, v255
  s_cbranch_vccnz L_rt_20
L_cd_21:
  v_add_f32 v96, v96, v100
  v_add_f32 v104, v104, v108
  v_add_f32 v97, v97, v101
  v_add_f32 v105, v105, v109
  v_add_f32 v98, v98, v102
  v_add_f32 v106, v106, v110
  v_add_f32 v99, v99, v103
  v_add_f32 v107, v107, v111
  v_add_f32 v96, v96, v104
  v_add_f32 v97, v97, v105
  v_add_f32 v98, v98, v106
  v_add_f32 v99, v99, v107
  v_mfma_f32_16x16x4_f32 v[112:115], v6, v96, 0
  v_mfma_f32_16x16x4_f32 v[116:119], v6, v97, 0
  v_mfma_f32_16x16x4_f32 v[120:123], v6, v98, 0
  v_mfma_f32_16x16x4_f32 v[124:127], v6, v99, 0
  v_bfe_u32 v100, v7, 3, 1
  v_lshlrev_b32 v100, 6, v100
  v_and_b32 v101, 3, v7
  v_lshl_add_u32 v100, v101, 4, v100
  v_bfe_u32 v101, v7, 2, 1
  v_lshl_add_u32 v100, v101, 3, v100
  v_add_u32 v100, 139264, v100
  s_nop 0
  v_cvt_pk_bf16_f32 v102, v112, v116
  s_nop 0
  v_cvt_pk_bf16_f32 v103, v120, v124
  s_mov_b64 exec, 0xffff
  ds_write_b64 v100, v[102:103]
  s_mov_b64 exec, -1
L_A_noz2:
  s_waitcnt lgkmcnt(0)
  s_barrier
  ds_read_b128 v[152:155], v234 offset:0
  ds_read_b128 v[156:159], v234 offset:1024
  ds_read_b128 v[160:163], v234 offset:2048
  ds_read_b128 v[164:167], v234 offset:3072
  ds_read_b128 v[168:171], v234 offset:4096
  ds_read_b128 v[172:175], v234 offset:5120
  ds_read_b128 v[176:179], v234 offset:6144
  ds_read_b128 v[180:183], v234 offset:7168
  v_add_u32 v255, 139264, v246
  ds_read_b128 v[188:191], v255 offset:0
  ds_read_b128 v[196:199], v255 offset:64
  s_waitcnt lgkmcnt(2)
  v_add_f32 v152, v152, v156
  v_add_f32 v153, v153, v157
  v_add_f32 v154, v154, v158
  v_add_f32 v155, v155, v159
  v_add_f32 v160, v160, v164
  v_add_f32 v161, v161, v165
  v_add_f32 v162, v162, v166
  v_add_f32 v163, v163, v167
  v_add_f32 v168, v168, v172
  v_add_f32 v169, v169, v173
  v_add_f32 v170, v170, v174
  v_add_f32 v171, v171, v175
  v_add_f32 v176, v176, v180
  v_add_f32 v177, v177, v181
  v_add_f32 v178, v178, v182
  v_add_f32 v179, v179, v183
  v_cvt_pk_bf16_f32 v184, v152, v153
  v_cvt_pk_bf16_f32 v185, v154, v155
  v_cvt_pk_bf16_f32 v186, v160, v161
  v_cvt_pk_bf16_f32 v187, v162, v163
  v_cvt_pk_bf16_f32 v192, v168, v169
  v_cvt_pk_bf16_f32 v193, v170, v171
  v_cvt_pk_bf16_f32 v194, v176, v177
  v_cvt_pk_bf16_f32 v195, v178, v179
  s_waitcnt lgkmcnt(0)
  v_mfma_f32_16x16x32_bf16 v[152:155], v[184:187], v[200:203], 0
  v_mfma_f32_16x16x32_bf16 v[156:159], v[188:191], v[200:203], 0
  v_mfma_f32_16x16x32_bf16 v[160:163], v[192:195], v[204:207], 0
  v_mfma_f32_16x16x32_bf16 v[164:167], v[196:199], v[204:207], 0
  s_nop 5
  v_cvt_pk_bf16_f32 v156, v156, v156
  s_nop 0
  v_cvt_pk_bf16_f32 v164, v164, v164
  v_lshlrev_b32 v156, 16, v156
  v_lshlrev_b32 v164, 16, v164
  v_add_f32 v156, 0x358637bd, v156
  v_add_f32 v164, 0x358637bd, v164
  v_cvt_pk_bf16_f32 v156, v156, v156
  v_cvt_pk_bf16_f32 v164, v164, v164
  v_lshlrev_b32 v156, 16, v156
  v_lshlrev_b32 v164, 16, v164
  v_rcp_f32 v156, v156
  v_rcp_f32 v164, v164
  v_cvt_pk_bf16_f32 v168, v152, v153
  v_cvt_pk_bf16_f32 v172, v160, v161
  v_cvt_pk_bf16_f32 v169, v154, v155
  v_cvt_pk_bf16_f32 v173, v162, v163
  v_lshlrev_b32 v152, 16, v168
  v_lshlrev_b32 v160, 16, v172
  v_and_b32 v153, 0xffff0000, v168
  v_and_b32 v161, 0xffff0000, v172
  v_lshlrev_b32 v154, 16, v169
  v_lshlrev_b32 v162, 16, v173
  v_and_b32 v155, 0xffff0000, v169
  v_and_b32 v163, 0xffff0000, v173
  v_mul_f32 v152, v152, v156
  v_mul_f32 v160, v160, v164
  v_mul_f32 v153, v153, v156
  v_mul_f32 v161, v161, v164
  v_mul_f32 v154, v154, v156
  v_mul_f32 v162, v162, v164
  v_mul_f32 v155, v155, v156
  v_mul_f32 v163, v163, v164
  v_cvt_pk_bf16_f32 v208, v152, v153
  v_cvt_pk_bf16_f32 v210, v160, v161
  v_cvt_pk_bf16_f32 v209, v154, v155
  v_cvt_pk_bf16_f32 v211, v162, v163
  s_cmp_eq_u32 s73, 0
  s_cbranch_scc1 L_ds_22
  buffer_store_dwordx4 v[208:211], v1, s[4:7], s42 offen
  s_branch L_dd_23
L_ds_22:
  buffer_store_dwordx4 v[208:211], v1, s[4:7], s42 offen sc1
L_dd_23:
  s_mul_i32 s53, s32, 12288
  s_add_u32 s52, s67, s53
  s_add_u32 s53, s53, 0
  s_mov_b32 m0, s53
  s_nop 0
  buffer_load_dwordx4 v1, s[4:7], s52 offen offset:0  lds
  buffer_load_dwordx4 v1, s[4:7], s52 offen offset:1024  lds
  buffer_load_dwordx4 v1, s[4:7], s52 offen offset:2048  lds
  buffer_load_dwordx4 v1, s[4:7], s52 offen offset:3072  lds
  s_add_u32 s52, s52, 4096
  s_add_u32 s53, s53, 4096
  s_mov_b32 m0, s53
  s_nop 0
  buffer_load_dwordx4 v1, s[4:7], s52 offen offset:0  lds
  buffer_load_dwordx4 v1, s[4:7], s52 offen offset:1024  lds
  buffer_load_dwordx4 v1, s[4:7], s52 offen offset:2048  lds
  buffer_load_dwordx4 v1, s[4:7], s52 offen offset:3072  lds
  s_add_u32 s52, s52, 4096
  s_add_u32 s53, s53, 4096
  s_mov_b32 m0, s53
  s_nop 0
  buffer_load_dwordx4 v1, s[4:7], s52 offen offset:0  lds
  buffer_load_dwordx4 v1, s[4:7], s52 offen offset:1024  lds
  buffer_load_dwordx4 v1, s[4:7], s52 offen offset:2048  lds
  buffer_load_dwordx4 v1, s[4:7], s52 offen offset:3072  lds
  s_cmp_lg_u32 s39, 0
  s_cbranch_scc1 L_noarm
  v_mov_b32 v152, -1
  v_mov_b32 v153, -1
  v_mov_b32 v154, -1
  v_mov_b32 v155, -1
  s_cmp_eq_u32 s73, 0
  s_cbranch_scc1 L_ds_24
  s_add_u32 s53, s42, 2097152
  buffer_store_dwordx4 v[152:155], v1, s[4:7], s53 offen
  s_add_u32 s53, s42, 4194304
  buffer_store_dwordx4 v[152:155], v1, s[4:7], s53 offen
  s_add_u32 s53, s42, 6291456
  buffer_store_dwordx4 v[152:155], v1, s[4:7], s53 offen
  s_add_u32 s53, s44, 2097152
  buffer_store_dwordx4 v[152:155], v1, s[4:7], s53 offen
  s_add_u32 s53, s44, 4194304
  buffer_store_dwordx4 v[152:155], v1, s[4:7], s53 offen
  s_mov_b64 exec, 0xffff
  s_add_u32 s53, s45, 262144
  buffer_store_dwordx2 v[152:153], v1, s[4:7], s53 offen
  s_add_u32 s53, s45, 524288
  buffer_store_dwordx2 v[152:153], v1, s[4:7], s53 offen
  s_mov_b64 exec, -1
  s_branch L_dd_25
L_ds_24:
  s_add_u32 s53, s42, 2097152
  buffer_store_dwordx4 v[152:155], v1, s[4:7], s53 offen sc1
  s_add_u32 s53, s42, 4194304
  buffer_store_dwordx4 v[152:155], v1, s[4:7], s53 offen sc1
  s_add_u32 s53, s42, 6291456
  buffer_store_dwordx4 v[152:155], v1, s[4:7], s53 offen sc1
  s_add_u32 s53, s44, 2097152
  buffer_store_dwordx4 v[152:155], v1, s[4:7], s53 offen sc1
  s_add_u32 s53, s44, 4194304
  buffer_store_dwordx4 v[152:155], v1, s[4:7], s53 offen sc1
  s_mov_b64 exec, 0xffff
  s_add_u32 s53, s45, 262144
  buffer_store_dwordx2 v[152:153], v1, s[4:7], s53 offen sc1
  s_add_u32 s53, s45, 524288
  buffer_store_dwordx2 v[152:153], v1, s[4:7], s53 offen sc1
  s_mov_b64 exec, -1
L_dd_25:
L_noarm:
  s_branch L_WO
  s_nop 15
  s_nop 3
L_B:
  s_cmp_lt_u32 s32, 6
  s_cbranch_scc1 L_B_nohc
  s_lshr_b32 s53, s39, 1
  s_lshl_b32 s53, s53, 4
  s_add_u32 s53, s53, s30
  s_lshl_b32 s53, s53, 1
  s_add_u32 s53, s53, s32
  s_sub_u32 s53, s53, 6
  s_lshl_b32 s54, s53, 11
  s_add_u32 s54, s54, s64
  s_add_u32 s54, s54, 23855104
  s_lshl_b32 s53, s53, 14
  s_lshl_b32 s55, s31, 10
  s_add_u32 s53, s53, s55
  s_add_u32 s53, s53, 23068672
  buffer_store_dwordx4 v[52:55], v1, s[4:7], s53 offen sc1
  s_mov_b64 exec, 0xffff
  buffer_store_dwordx2 v[4:5], v1, s[4:7], s54 offen sc1
  s_mov_b64 exec, -1
  s_branch L_B_hc2
L_B_nohc:
  s_mov_b64 exec, 1
  buffer_load_dword v233, v1, s[4:7], s41 offen
  buffer_load_dword v233, v1, s[4:7], s41 offen
  s_mov_b64 exec, -1
L_B_hc2:
  s_cmp_lt_u32 s32, 4
  s_cselect_b32 s69, s30, 0
  v_bfe_u32 v200, v7, 3, 1
  v_lshlrev_b32 v201, 14, v200
  v_or_b32 v202, 128, v1
  v_add_u32 v201, v201, v202
  s_lshr_b32 s57, s39, 1
  s_lshl_b32 s57, s57, 4
  s_add_u32 s57, s57, s30
  s_sub_u32 s57, s57, 1
  s_lshl_b32 s54, s57, 15
  s_add_u32 s54, s54, 23068672
  s_lshl_b32 s55, s32, 12
  s_add_u32 s54, s54, s55
  v_or_b32 v202, 128, v247
  s_lshl_b32 s55, s57, 12
  s_lshl_b32 s57, s32, 11
  s_add_u32 s55, s55, s57
  s_add_u32 s55, s55, 24117248
  ds_read_b128 v[152:155], v1 offset:2048
  ds_read_b128 v[156:159], v1 offset:3072
  ds_read_b128 v[160:163], v1 offset:4096
  ds_read_b128 v[164:167], v1 offset:5120
  ds_read_b128 v[168:171], v1 offset:8192
  ds_read_b128 v[172:175], v1 offset:9216
  ds_read_b128 v[176:179], v1 offset:10240
  ds_read_b128 v[180:183], v1 offset:11264
  s_waitcnt vmcnt(6)
  s_mov_b32 s56, 0
L_chk_26:
  v_max3_u32 v255, v64, v65, v66
  v_max3_u32 v255, v255, v67, v68
  v_max3_u32 v255, v255, v69, v70
  v_max3_u32 v255, v255, v71, v72
  v_max3_u32 v255, v255, v73, v74
  v_max3_u32 v255, v255, v75, v76
  v_max3_u32 v255, v255, v77, v78
  v_max_u32 v255, v255, v79
  v_cmp_eq_u32 vcc, -1, v255
  s_cbranch_vccnz L_rt_27
L_cd_28:
  s_add_u32 s58, s40, 8192
  buffer_load_dwordx4 v[96:99], v1, s[4:7], s58 offen offset:0 sc1
  buffer_load_dwordx4 v[100:103], v1, s[4:7], s58 offen offset:1024 sc1
  buffer_load_dwordx4 v[104:107], v1, s[4:7], s58 offen offset:2048 sc1
  buffer_load_dwordx4 v[108:111], v1, s[4:7], s58 offen offset:3072 sc1
  buffer_load_dwordx4 v[224:227], v247, s[4:7], s41 offen sc1
  buffer_load_dwordx4 v[228:231], v247, s[4:7], s41 offen offset:256 sc1
  s_waitcnt lgkmcnt(7)
  v_mfma_f32_16x16x32_bf16 v[128:131], v[152:155], v[64:67], 0
  ds_read_b128 v[184:187], v1 offset:14336
  s_waitcnt lgkmcnt(7)
  v_mfma_f32_16x16x32_bf16 v[132:135], v[156:159], v[64:67], 0
  ds_read_b128 v[152:155], v1 offset:15360
  s_waitcnt lgkmcnt(7)
  v_mfma_f32_16x16x32_bf16 v[136:139], v[64:67], v[160:163], 0
  ds_read_b128 v[156:159], v1 offset:16384
  s_waitcnt lgkmcnt(7)
  v_mfma_f32_16x16x32_bf16 v[140:143], v[64:67], v[164:167], 0
  ds_read_b128 v[160:163], v1 offset:17408
  s_waitcnt lgkmcnt(7)
  v_mfma_f32_16x16x32_bf16 v[128:131], v[168:171], v[68:71], v[128:131]
  ds_read_b128 v[164:167], v1 offset:20480
  s_waitcnt lgkmcnt(7)
  v_mfma_f32_16x16x32_bf16 v[132:135], v[172:175], v[68:71], v[132:135]
  ds_read_b128 v[168:171], v1 offset:21504
  s_waitcnt lgkmcnt(7)
  v_mfma_f32_16x16x32_bf16 v[136:139], v[68:71], v[176:179], v[136:139]
  ds_read_b128 v[172:175], v1 offset:22528
  s_waitcnt lgkmcnt(7)
  v_mfma_f32_16x16x32_bf16 v[140:143], v[68:71], v[180:183], v[140:143]
  ds_read_b128 v[176:179], v1 offset:23552
  s_waitcnt lgkmcnt(7)
  v_mfma_f32_16x16x32_bf16 v[128:131], v[184:187], v[72:75], v[128:131]
  ds_read_b128 v[180:183], v1 offset:26624
  s_waitcnt lgkmcnt(7)
  v_mfma_f32_16x16x32_bf16 v[132:135], v[152:155], v[72:75], v[132:135]
  ds_read_b128 v[184:187], v1 offset:27648
  s_waitcnt lgkmcnt(7)
  v_mfma_f32_16x16x32_bf16 v[136:139], v[72:75], v[156:159], v[136:139]
  ds_read_b128 v[152:155], v1 offset:28672
  s_waitcnt lgkmcnt(7)
  v_mfma_f32_16x16x32_bf16 v[140:143], v[72:75], v[160:163], v[140:143]
  ds_read_b128 v[156:159], v1 offset:29696
  s_waitcnt lgkmcnt(7)
  v_mfma_f32_16x16x32_bf16 v[128:131], v[164:167], v[76:79], v[128:131]
  ds_read_b128 v[160:163], v1 offset:32768
  s_waitcnt lgkmcnt(7)
  v_mfma_f32_16x16x32_bf16 v[132:135], v[168:171], v[76:79], v[132:135]
  ds_read_b128 v[164:167], v1 offset:33792
  s_waitcnt lgkmcnt(7)
  v_mfma_f32_16x16x32_bf16 v[136:139], v[76:79], v[172:175], v[136:139]
  ds_read_b128 v[168:171], v1 offset:34816
  s_waitcnt lgkmcnt(7)
  v_mfma_f32_16x16x32_bf16 v[140:143], v[76:79], v[176:179], v[140:143]
  ds_read_b128 v[172:175], v1 offset:35840
  s_waitcnt vmcnt(8)
  s_mov_b32 s56, 0
L_chk_29:
  v_max3_u32 v255, v80, v81, v82
  v_max3_u32 v255, v255, v83, v84
  v_max3_u32 v255, v255, v85, v86
  v_max3_u32 v255, v255, v87, v88
  v_max3_u32 v255, v255, v89, v90
  v_max3_u32 v255, v255, v91, v92
  v_max3_u32 v255, v255, v93, v94
  v_max_u32 v255, v255, v95
  v_cmp_eq_u32 vcc, -1, v255
  s_cbranch_vccnz L_rt_30
L_cd_31:
  s_add_u32 s58, s40, 12288
  buffer_load_dwordx4 v[112:115], v1, s[4:7], s58 offen offset:0 sc1
  buffer_load_dwordx4 v[116:119], v1, s[4:7], s58 offen offset:1024 sc1
  buffer_load_dwordx4 v[120:123], v1, s[4:7], s58 offen offset:2048 sc1
  buffer_load_dwordx4 v[124:127], v1, s[4:7], s58 offen offset:3072 sc1
  s_waitcnt lgkmcnt(7)
  v_mfma_f32_16x16x32_bf16 v[128:131], v[180:183], v[80:83], v[128:131]
  ds_read_b128 v[176:179], v1 offset:38912
  s_waitcnt lgkmcnt(7)
  v_mfma_f32_16x16x32_bf16 v[132:135], v[184:187], v[80:83], v[132:135]
  ds_read_b128 v[180:183], v1 offset:39936
  s_waitcnt lgkmcnt(7)
  v_mfma_f32_16x16x32_bf16 v[136:139], v[80:83], v[152:155], v[136:139]
  ds_read_b128 v[184:187], v1 offset:40960
  s_waitcnt lgkmcnt(7)
  v_mfma_f32_16x16x32_bf16 v[140:143], v[80:83], v[156:159], v[140:143]
  ds_read_b128 v[152:155], v1 offset:41984
  s_waitcnt lgkmcnt(7)
  v_mfma_f32_16x16x32_bf16 v[128:131], v[160:163], v[84:87], v[128:131]
  ds_read_b128 v[156:159], v1 offset:45056
  s_waitcnt lgkmcnt(7)
  v_mfma_f32_16x16x32_bf16 v[132:135], v[164:167], v[84:87], v[132:135]
  ds_read_b128 v[160:163], v1 offset:46080
  s_waitcnt lgkmcnt(7)
  v_mfma_f32_16x16x32_bf16 v[136:139], v[84:87], v[168:171], v[136:139]
  ds_read_b128 v[164:167], v1 offset:47104
  s_waitcnt lgkmcnt(7)
  v_mfma_f32_16x16x32_bf16 v[140:143], v[84:87], v[172:175], v[140:143]
  ds_read_b128 v[168:171], v1 offset:48128
  s_waitcnt lgkmcnt(7)
  v_mfma_f32_16x16x32_bf16 v[128:131], v[176:179], v[88:91], v[128:131]
  ds_read_b128 v[172:175], v2 offset:2048
  s_waitcnt lgkmcnt(7)
  v_mfma_f32_16x16x32_bf16 v[132:135], v[180:183], v[88:91], v[132:135]
  ds_read_b128 v[176:179], v2 offset:3072
  s_waitcnt lgkmcnt(7)
  v_mfma_f32_16x16x32_bf16 v[136:139], v[88:91], v[184:187], v[136:139]
  ds_read_b128 v[180:183], v2 offset:4096
  s_waitcnt lgkmcnt(7)
  v_mfma_f32_16x16x32_bf16 v[140:143], v[88:91], v[152:155], v[140:143]
  ds_read_b128 v[184:187], v2 offset:5120
  s_waitcnt lgkmcnt(7)
  v_mfma_f32_16x16x32_bf16 v[128:131], v[156:159], v[92:95], v[128:131]
  ds_read_b128 v[152:155], v2 offset:8192
  s_waitcnt lgkmcnt(7)
  v_mfma_f32_16x16x32_bf16 v[132:135], v[160:163], v[92:95], v[132:135]
  ds_read_b128 v[156:159], v2 offset:9216
  s_waitcnt lgkmcnt(7)
  v_mfma_f32_16x16x32_bf16 v[136:139], v[92:95], v[164:167], v[136:139]
  ds_read_b128 v[160:163], v2 offset:10240
  s_waitcnt lgkmcnt(7)
  v_mfma_f32_16x16x32_bf16 v[140:143], v[92:95], v[168:171], v[140:143]
  ds_read_b128 v[164:167], v2 offset:11264
  s_waitcnt vmcnt(6)
  s_mov_b32 s56, 0
L_chk_32:
  v_max3_u32 v255, v96, v97, v98
  v_max3_u32 v255, v255, v99, v100
  v_max3_u32 v255, v255, v101, v102
  v_max3_u32 v255, v255, v103, v104
  v_max3_u32 v255, v255, v105, v106
  v_max3_u32 v255, v255, v107, v108
  v_max3_u32 v255, v255, v109, v110
  v_max_u32 v255, v255, v111
  v_cmp_eq_u32 vcc, -1, v255
  s_cbranch_vccnz L_rt_33
L_cd_34:
  s_mul_i32 s53, s32, 4096
  s_add_u32 s52, s66, s53
  s_add_u32 s53, s53, 98304
  s_mov_b32 m0, s53
  s_nop 0
  buffer_load_dwordx4 v1, s[4:7], s52 offen offset:0  lds
  buffer_load_dwordx4 v1, s[4:7], s52 offen offset:1024  lds
  buffer_load_dwordx4 v1, s[4:7], s52 offen offset:2048  lds
  buffer_load_dwordx4 v1, s[4:7], s52 offen offset:3072  lds
  s_waitcnt lgkmcnt(7)
  v_mfma_f32_16x16x32_bf16 v[128:131], v[172:175], v[96:99], v[128:131]
  ds_read_b128 v[168:171], v2 offset:14336
  s_waitcnt lgkmcnt(7)
  v_mfma_f32_16x16x32_bf16 v[132:135], v[176:179], v[96:99], v[132:135]
  ds_read_b128 v[172:175], v2 offset:15360
  s_waitcnt lgkmcnt(7)
  v_mfma_f32_16x16x32_bf16 v[136:139], v[96:99], v[180:183], v[136:139]
  ds_read_b128 v[176:179], v2 offset:16384
  s_waitcnt lgkmcnt(7)
  v_mfma_f32_16x16x32_bf16 v[140:143], v[96:99], v[184:187], v[140:143]
  ds_read_b128 v[180:183], v2 offset:17408
  s_waitcnt lgkmcnt(7)
  v_mfma_f32_16x16x32_bf16 v[128:131], v[152:155], v[100:103], v[128:131]
  ds_read_b128 v[184:187], v2 offset:20480
  s_waitcnt lgkmcnt(7)
  v_mfma_f32_16x16x32_bf16 v[132:135], v[156:159], v[100:103], v[132:135]
  ds_read_b128 v[152:155], v2 offset:21504
  s_waitcnt lgkmcnt(7)
  v_mfma_f32_16x16x32_bf16 v[136:139], v[100:103], v[160:163], v[136:139]
  ds_read_b128 v[156:159], v2 offset:22528
  s_waitcnt lgkmcnt(7)
  v_mfma_f32_16x16x32_bf16 v[140:143], v[100:103], v[164:167], v[140:143]
  ds_read_b128 v[160:163], v2 offset:23552
  s_waitcnt lgkmcnt(7)
  v_mfma_f32_16x16x32_bf16 v[128:131], v[168:171], v[104:107], v[128:131]
  ds_read_b128 v[164:167], v2 offset:26624
  s_waitcnt lgkmcnt(7)
  v_mfma_f32_16x16x32_bf16 v[132:135], v[172:175], v[104:107], v[132:135]
  ds_read_b128 v[168:171], v2 offset:27648
  s_waitcnt lgkmcnt(7)
  v_mfma_f32_16x16x32_bf16 v[136:139], v[104:107], v[176:179], v[136:139]
  ds_read_b128 v[172:175], v2 offset:28672
  s_waitcnt lgkmcnt(7)
  v_mfma_f32_16x16x32_bf16 v[140:143], v[104:107], v[180:183], v[140:143]
  ds_read_b128 v[176:179], v2 offset:29696
  s_waitcnt lgkmcnt(7)
  v_mfma_f32_16x16x32_bf16 v[128:131], v[184:187], v[108:111], v[128:131]
  ds_read_b128 v[180:183], v2 offset:32768
  s_waitcnt lgkmcnt(7)
  v_mfma_f32_16x16x32_bf16 v[132:135], v[152:155], v[108:111], v[132:135]
  ds_read_b128 v[184:187], v2 offset:33792
  s_waitcnt lgkmcnt(7)
  v_mfma_f32_16x16x32_bf16 v[136:139], v[108:111], v[156:159], v[136:139]
  ds_read_b128 v[152:155], v2 offset:34816
  s_waitcnt lgkmcnt(7)
  v_mfma_f32_16x16x32_bf16 v[140:143], v[108:111], v[160:163], v[140:143]
  ds_read_b128 v[156:159], v2 offset:35840
  s_waitcnt vmcnt(4)
  s_mov_b32 s56, 0
L_chk_35:
  v_max3_u32 v255, v112, v113, v114
  v_max3_u32 v255, v255, v115, v116
  v_max3_u32 v255, v255, v117, v118
  v_max3_u32 v255, v255, v119, v120
  v_max3_u32 v255, v255, v121, v122
  v_max3_u32 v255, v255, v123, v124
  v_max3_u32 v255, v255, v125, v126
  v_max_u32 v255, v255, v127
  v_cmp_eq_u32 vcc, -1, v255
  s_cbranch_vccnz L_rt_36
L_cd_37:
  s_mov_b32 s56, 0
L_chk_38:
  v_max3_u32 v255, v224, v225, v226
  v_max3_u32 v255, v255, v227, v228
  v_max3_u32 v255, v255, v229, v230
  v_max_u32 v255, v255, v231
  v_cmp_eq_u32 vcc, -1, v255
  s_cbranch_vccnz L_rt_39
L_cd_40:
  v_add_f32 v224, v224, v226
  v_add_f32 v225, v225, v227
  v_add_f32 v228, v228, v230
  v_add_f32 v229, v229, v231
  v_add_f32 v224, v224, v228
  v_add_f32 v225, v225, v229
  s_nop 0
  v_mfma_f32_16x16x4_f32 v[208:211], v6, v224, 0
  v_mfma_f32_16x16x4_f32 v[212:215], v6, v225, 0
  s_nop 8
  v_mul_f32 v208, 0x3b000000, v208
  v_mul_f32 v212, 0x3b000000, v212
  v_fma_f32 v212, -v208, v208, v212
  v_max_f32 v212, 0, v212
  v_cvt_pk_bf16_f32 v209, v208, v212
  v_lshlrev_b32 v252, 16, v209
  v_and_b32 v212, 0xffff0000, v209
  v_add_f32 v212, 0x3727c5ac, v212
  v_cvt_pk_bf16_f32 v212, v212, v212
  v_lshlrev_b32 v212, 16, v212
  v_sqrt_f32 v212, v212
  s_nop 0
  v_cvt_pk_bf16_f32 v212, v212, v212
  v_lshlrev_b32 v212, 16, v212
  v_rcp_f32 v253, v212
  ds_bpermute_b32 v236, v246, v252 offset:0
  ds_bpermute_b32 v240, v246, v253 offset:0
  ds_bpermute_b32 v237, v246, v252 offset:4
  ds_bpermute_b32 v241, v246, v253 offset:4
  ds_bpermute_b32 v238, v246, v252 offset:8
  ds_bpermute_b32 v242, v246, v253 offset:8
  ds_bpermute_b32 v239, v246, v252 offset:12
  ds_bpermute_b32 v243, v246, v253 offset:12
  s_waitcnt lgkmcnt(7)
  v_mfma_f32_16x16x32_bf16 v[128:131], v[164:167], v[112:115], v[128:131]
  ds_read_b128 v[160:163], v2 offset:38912
  s_waitcnt lgkmcnt(7)
  v_mfma_f32_16x16x32_bf16 v[132:135], v[168:171], v[112:115], v[132:135]
  ds_read_b128 v[164:167], v2 offset:39936
  s_waitcnt lgkmcnt(7)
  v_mfma_f32_16x16x32_bf16 v[136:139], v[112:115], v[172:175], v[136:139]
  ds_read_b128 v[168:171], v2 offset:40960
  s_waitcnt lgkmcnt(7)
  v_mfma_f32_16x16x32_bf16 v[140:143], v[112:115], v[176:179], v[140:143]
  ds_read_b128 v[172:175], v2 offset:41984
  s_waitcnt lgkmcnt(7)
  v_mfma_f32_16x16x32_bf16 v[128:131], v[180:183], v[116:119], v[128:131]
  ds_read_b128 v[176:179], v2 offset:45056
  s_waitcnt lgkmcnt(7)
  v_mfma_f32_16x16x32_bf16 v[132:135], v[184:187], v[116:119], v[132:135]
  ds_read_b128 v[180:183], v2 offset:46080
  s_waitcnt lgkmcnt(7)
  v_mfma_f32_16x16x32_bf16 v[136:139], v[116:119], v[152:155], v[136:139]
  ds_read_b128 v[184:187], v2 offset:47104
  s_waitcnt lgkmcnt(7)
  v_mfma_f32_16x16x32_bf16 v[140:143], v[116:119], v[156:159], v[140:143]
  ds_read_b128 v[152:155], v2 offset:48128
  s_waitcnt lgkmcnt(7)
  v_mfma_f32_16x16x32_bf16 v[128:131], v[160:163], v[120:123], v[128:131]
  s_waitcnt lgkmcnt(6)
  v_mfma_f32_16x16x32_bf16 v[132:135], v[164:167], v[120:123], v[132:135]
  s_waitcnt lgkmcnt(5)
  v_mfma_f32_16x16x32_bf16 v[136:139], v[120:123], v[168:171], v[136:139]
  s_waitcnt lgkmcnt(4)
  v_mfma_f32_16x16x32_bf16 v[140:143], v[120:123], v[172:175], v[140:143]
  s_waitcnt lgkmcnt(3)
  v_mfma_f32_16x16x32_bf16 v[128:131], v[176:179], v[124:127], v[128:131]
  s_waitcnt lgkmcnt(2)
  v_mfma_f32_16x16x32_bf16 v[132:135], v[180:183], v[124:127], v[132:135]
  s_waitcnt lgkmcnt(1)
  v_mfma_f32_16x16x32_bf16 v[136:139], v[124:127], v[184:187], v[136:139]
  s_waitcnt lgkmcnt(0)
  v_mfma_f32_16x16x32_bf16 v[140:143], v[124:127], v[152:155], v[140:143]
  s_cmp_eq_u32 s69, 0
  s_cbranch_scc1 L_B_nh4
  buffer_load_dwordx4 v[208:211], v201, s[4:7], s54 offen offset:0 sc1
  buffer_load_dwordx4 v[212:215], v201, s[4:7], s54 offen offset:1024 sc1
  buffer_load_dwordx4 v[216:219], v201, s[4:7], s54 offen offset:2048 sc1
  buffer_load_dwordx4 v[220:223], v201, s[4:7], s54 offen offset:3072 sc1
  s_cmp_ge_u32 s32, 2
  s_cbranch_scc1 L_B_nh4
  buffer_load_dwordx4 v[224:227], v202, s[4:7], s55 offen sc1
  buffer_load_dwordx4 v[228:231], v202, s[4:7], s55 offen offset:256 sc1
L_B_nh4:
  s_mul_i32 s53, s32, 12288
  s_add_u32 s52, s67, s53
  buffer_load_dword v233, v15, s[4:7], s52 offen
  s_add_u32 s52, s52, 4096
  buffer_load_dword v233, v15, s[4:7], s52 offen
  v_fma_f32 v128, -v252, v42, v128
  v_fma_f32 v132, -v252, v46, v132
  v_fma_f32 v136, -v236, v50, v136
  v_fma_f32 v140, -v236, v51, v140
  v_fma_f32 v129, -v252, v43, v129
  v_fma_f32 v133, -v252, v47, v133
  v_fma_f32 v137, -v237, v50, v137
  v_fma_f32 v141, -v237, v51, v141
  v_fma_f32 v130, -v252, v44, v130
  v_fma_f32 v134, -v252, v48, v134
  v_fma_f32 v138, -v238, v50, v138
  v_fma_f32 v142, -v238, v51, v142
  v_fma_f32 v131, -v252, v45, v131
  v_fma_f32 v135, -v252, v49, v135
  v_fma_f32 v139, -v239, v50, v139
  v_fma_f32 v143, -v239, v51, v143
  v_mul_f32 v128, v128, v253
  v_mul_f32 v132, v132, v253
  v_mul_f32 v136, v136, v240
  v_mul_f32 v140, v140, v240
  v_mul_f32 v129, v129, v253
  v_mul_f32 v133, v133, v253
  v_mul_f32 v137, v137, v241
  v_mul_f32 v141, v141, v241
  v_mul_f32 v130, v130, v253
  v_mul_f32 v134, v134, v253
  v_mul_f32 v138, v138, v242
  v_mul_f32 v142, v142, v242
  v_mul_f32 v131, v131, v253
  v_mul_f32 v135, v135, v253
  v_mul_f32 v139, v139, v243
  v_mul_f32 v143, v143, v243
  v_cvt_pk_bf16_f32 v188, v128, v129
  v_cvt_pk_bf16_f32 v190, v132, v133
  v_cvt_pk_bf16_f32 v192, v136, v137
  v_cvt_pk_bf16_f32 v194, v140, v141
  v_cvt_pk_bf16_f32 v189, v130, v131
  v_cvt_pk_bf16_f32 v191, v134, v135
  v_cvt_pk_bf16_f32 v193, v138, v139
  v_cvt_pk_bf16_f32 v195, v142, v143
  s_lshl_b32 s53, s32, 11
  v_add_u32 v200, s53, v234
  s_cmp_ge_u32 s32, 6
  s_cbranch_scc1 L_B_nowr
  ds_write_b128 v200, v[188:191] offset:4096
  ds_write_b128 v200, v[192:195] offset:5120
L_B_nowr:
  ds_read_b128 v[152:155], v1 offset:0
  ds_read_b128 v[156:159], v1 offset:1024
  ds_read_b128 v[160:163], v1 offset:6144
  ds_read_b128 v[164:167], v1 offset:7168
  ds_read_b128 v[168:171], v1 offset:12288
  ds_read_b128 v[172:175], v1 offset:13312
  ds_read_b128 v[176:179], v1 offset:18432
  ds_read_b128 v[180:183], v1 offset:19456
  s_waitcnt lgkmcnt(7)
  v_mfma_f32_16x16x32_bf16 v[144:147], v[152:155], v[64:67], 0
  ds_read_b128 v[184:187], v1 offset:24576
  s_waitcnt lgkmcnt(7)
  v_mfma_f32_16x16x32_bf16 v[148:151], v[156:159], v[64:67], 0
  ds_read_b128 v[152:155], v1 offset:25600
  s_waitcnt lgkmcnt(7)
  v_mfma_f32_16x16x32_bf16 v[144:147], v[160:163], v[68:71], v[144:147]
  ds_read_b128 v[156:159], v1 offset:30720
  s_waitcnt lgkmcnt(7)
  v_mfma_f32_16x16x32_bf16 v[148:151], v[164:167], v[68:71], v[148:151]
  ds_read_b128 v[160:163], v1 offset:31744
  s_waitcnt lgkmcnt(7)
  v_mfma_f32_16x16x32_bf16 v[144:147], v[168:171], v[72:75], v[144:147]
  ds_read_b128 v[164:167], v1 offset:36864
  s_waitcnt lgkmcnt(7)
  v_mfma_f32_16x16x32_bf16 v[148:151], v[172:175], v[72:75], v[148:151]
  ds_read_b128 v[168:171], v1 offset:37888
  s_waitcnt lgkmcnt(7)
  v_mfma_f32_16x16x32_bf16 v[144:147], v[176:179], v[76:79], v[144:147]
  ds_read_b128 v[172:175], v1 offset:43008
  s_waitcnt lgkmcnt(7)
  v_mfma_f32_16x16x32_bf16 v[148:151], v[180:183], v[76:79], v[148:151]
  ds_read_b128 v[176:179], v1 offset:44032
  s_waitcnt lgkmcnt(7)
  v_mfma_f32_16x16x32_bf16 v[144:147], v[184:187], v[80:83], v[144:147]
  ds_read_b128 v[180:183], v2 offset:0
  s_waitcnt lgkmcnt(7)
  v_mfma_f32_16x16x32_bf16 v[148:151], v[152:155], v[80:83], v[148:151]
  ds_read_b128 v[184:187], v2 offset:1024
  s_waitcnt lgkmcnt(7)
  v_mfma_f32_16x16x32_bf16 v[144:147], v[156:159], v[84:87], v[144:147]
  ds_read_b128 v[152:155], v2 offset:6144
  s_waitcnt lgkmcnt(7)
  v_mfma_f32_16x16x32_bf16 v[148:151], v[160:163], v[84:87], v[148:151]
  ds_read_b128 v[156:159], v2 offset:7168
  s_waitcnt lgkmcnt(7)
  v_mfma_f32_16x16x32_bf16 v[144:147], v[164:167], v[88:91], v[144:147]
  ds_read_b128 v[160:163], v2 offset:12288
  s_waitcnt lgkmcnt(7)
  v_mfma_f32_16x16x32_bf16 v[148:151], v[168:171], v[88:91], v[148:151]
  ds_read_b128 v[164:167], v2 offset:13312
  s_waitcnt lgkmcnt(7)
  v_mfma_f32_16x16x32_bf16 v[144:147], v[172:175], v[92:95], v[144:147]
  ds_read_b128 v[168:171], v2 offset:18432
  s_waitcnt lgkmcnt(7)
  v_mfma_f32_16x16x32_bf16 v[148:151], v[176:179], v[92:95], v[148:151]
  ds_read_b128 v[172:175], v2 offset:19456
  s_waitcnt lgkmcnt(7)
  v_mfma_f32_16x16x32_bf16 v[144:147], v[180:183], v[96:99], v[144:147]
  ds_read_b128 v[176:179], v2 offset:24576
  s_waitcnt lgkmcnt(7)
  v_mfma_f32_16x16x32_bf16 v[148:151], v[184:187], v[96:99], v[148:151]
  ds_read_b128 v[180:183], v2 offset:25600
  s_waitcnt lgkmcnt(7)
  v_mfma_f32_16x16x32_bf16 v[144:147], v[152:155], v[100:103], v[144:147]
  ds_read_b128 v[184:187], v2 offset:30720
  s_waitcnt lgkmcnt(7)
  v_mfma_f32_16x16x32_bf16 v[148:151], v[156:159], v[100:103], v[148:151]
  ds_read_b128 v[152:155], v2 offset:31744
  s_waitcnt lgkmcnt(7)
  v_mfma_f32_16x16x32_bf16 v[144:147], v[160:163], v[104:107], v[144:147]
  ds_read_b128 v[156:159], v2 offset:36864
  s_waitcnt lgkmcnt(7)
  v_mfma_f32_16x16x32_bf16 v[148:151], v[164:167], v[104:107], v[148:151]
  ds_read_b128 v[160:163], v2 offset:37888
  s_waitcnt lgkmcnt(7)
  v_mfma_f32_16x16x32_bf16 v[144:147], v[168:171], v[108:111], v[144:147]
  ds_read_b128 v[164:167], v2 offset:43008
  s_waitcnt lgkmcnt(7)
  v_mfma_f32_16x16x32_bf16 v[148:151], v[172:175], v[108:111], v[148:151]
  ds_read_b128 v[168:171], v2 offset:44032
  s_waitcnt lgkmcnt(7)
  v_mfma_f32_16x16x32_bf16 v[144:147], v[176:179], v[112:115], v[144:147]
  s_waitcnt lgkmcnt(6)
  v_mfma_f32_16x16x32_bf16 v[148:151], v[180:183], v[112:115], v[148:151]
  s_waitcnt lgkmcnt(5)
  v_mfma_f32_16x16x32_bf16 v[144:147], v[184:187], v[116:119], v[144:147]
  s_waitcnt lgkmcnt(4)
  v_mfma_f32_16x16x32_bf16 v[148:151], v[152:155], v[116:119], v[148:151]
  s_waitcnt lgkmcnt(3)
  v_mfma_f32_16x16x32_bf16 v[144:147], v[156:159], v[120:123], v[144:147]
  s_waitcnt lgkmcnt(2)
  v_mfma_f32_16x16x32_bf16 v[148:151], v[160:163], v[120:123], v[148:151]
  s_waitcnt lgkmcnt(1)
  v_mfma_f32_16x16x32_bf16 v[144:147], v[164:167], v[124:127], v[144:147]
  s_waitcnt lgkmcnt(0)
  v_mfma_f32_16x16x32_bf16 v[148:151], v[168:171], v[124:127], v[148:151]
  s_cmp_eq_u32 s69, 0
  s_cbranch_scc1 L_B_nh3
  s_mul_i32 s53, s32, 24576
  v_add_u32 v203, s53, v1
  s_waitcnt vmcnt(2)
  s_mov_b32 s56, 0
L_chk_41:
  v_max3_u32 v255, v208, v209, v210
  v_max3_u32 v255, v255, v211, v212
  v_max3_u32 v255, v255, v213, v214
  v_max3_u32 v255, v255, v215, v216
  v_max3_u32 v255, v255, v217, v218
  v_max3_u32 v255, v255, v219, v220
  v_max3_u32 v255, v255, v221, v222
  v_max_u32 v255, v255, v223
  v_cmp_eq_u32 vcc, -1, v255
  s_cbranch_vccnz L_rt_42
L_cd_43:
  ds_read_b128 v[152:155], v203 offset:2048
  ds_read_b128 v[156:159], v203 offset:3072
  ds_read_b128 v[160:163], v203 offset:4096
  ds_read_b128 v[164:167], v203 offset:5120
  ds_read_b128 v[168:171], v203 offset:8192
  ds_read_b128 v[172:175], v203 offset:9216
  ds_read_b128 v[176:179], v203 offset:10240
  ds_read_b128 v[180:183], v203 offset:11264
  s_waitcnt lgkmcnt(7)
  v_mfma_f32_16x16x32_bf16 v[128:131], v[152:155], v[208:211], 0
  ds_read_b128 v[184:187], v203 offset:14336
  s_waitcnt lgkmcnt(7)
  v_mfma_f32_16x16x32_bf16 v[132:135], v[156:159], v[208:211], 0
  ds_read_b128 v[152:155], v203 offset:15360
  s_waitcnt lgkmcnt(7)
  v_mfma_f32_16x16x32_bf16 v[136:139], v[208:211], v[160:163], 0
  ds_read_b128 v[156:159], v203 offset:16384
  s_waitcnt lgkmcnt(7)
  v_mfma_f32_16x16x32_bf16 v[140:143], v[208:211], v[164:167], 0
  ds_read_b128 v[160:163], v203 offset:17408
  s_waitcnt lgkmcnt(7)
  v_mfma_f32_16x16x32_bf16 v[128:131], v[168:171], v[212:215], v[128:131]
  ds_read_b128 v[164:167], v203 offset:20480
  s_waitcnt lgkmcnt(7)
  v_mfma_f32_16x16x32_bf16 v[132:135], v[172:175], v[212:215], v[132:135]
  ds_read_b128 v[168:171], v203 offset:21504
  s_waitcnt lgkmcnt(7)
  v_mfma_f32_16x16x32_bf16 v[136:139], v[212:215], v[176:179], v[136:139]
  ds_read_b128 v[172:175], v203 offset:22528
  s_waitcnt lgkmcnt(7)
  v_mfma_f32_16x16x32_bf16 v[140:143], v[212:215], v[180:183], v[140:143]
  ds_read_b128 v[176:179], v203 offset:23552
  s_waitcnt lgkmcnt(7)
  v_mfma_f32_16x16x32_bf16 v[128:131], v[184:187], v[216:219], v[128:131]
  s_waitcnt lgkmcnt(6)
  v_mfma_f32_16x16x32_bf16 v[132:135], v[152:155], v[216:219], v[132:135]
  s_waitcnt lgkmcnt(5)
  v_mfma_f32_16x16x32_bf16 v[136:139], v[216:219], v[156:159], v[136:139]
  s_waitcnt lgkmcnt(4)
  v_mfma_f32_16x16x32_bf16 v[140:143], v[216:219], v[160:163], v[140:143]
  s_waitcnt lgkmcnt(3)
  v_mfma_f32_16x16x32_bf16 v[128:131], v[164:167], v[220:223], v[128:131]
  s_waitcnt lgkmcnt(2)
  v_mfma_f32_16x16x32_bf16 v[132:135], v[168:171], v[220:223], v[132:135]
  s_waitcnt lgkmcnt(1)
  v_mfma_f32_16x16x32_bf16 v[136:139], v[220:223], v[172:175], v[136:139]
  s_waitcnt lgkmcnt(0)
  v_mfma_f32_16x16x32_bf16 v[140:143], v[220:223], v[176:179], v[140:143]
  s_lshl_b32 s53, s32, 12
  s_add_u32 s53, s53, 16384
  v_add_u32 v203, s53, v234
  ds_write_b128 v203, v[128:131] offset:0
  ds_write_b128 v203, v[132:135] offset:1024
  s_nop 0
  ds_write_b128 v203, v[136:139] offset:2048
  s_nop 0
  ds_write_b128 v203, v[140:143] offset:3072
  s_cmp_ge_u32 s32, 2
  s_cbranch_scc1 L_B_nh3
  s_mov_b32 s56, 0
L_chk_44:
  v_max3_u32 v255, v224, v225, v226
  v_max3_u32 v255, v255, v227, v228
  v_max3_u32 v255, v255, v229, v230
  v_max_u32 v255, v255, v231
  v_cmp_eq_u32 vcc, -1, v255
  s_cbranch_vccnz L_rt_45
L_cd_46:
  v_add_f32 v224, v224, v226
  v_add_f32 v225, v225, v227
  v_add_f32 v228, v228, v230
  v_add_f32 v229, v229, v231
  v_add_f32 v224, v224, v228
  v_add_f32 v225, v225, v229
  s_nop 0
  v_mfma_f32_16x16x4_f32 v[208:211], v6, v224, 0
  v_mfma_f32_16x16x4_f32 v[212:215], v6, v225, 0
  s_nop 8
  v_mul_f32 v208, 0x3b000000, v208
  v_mul_f32 v212, 0x3b000000, v212
  v_fma_f32 v212, -v208, v208, v212
  v_max_f32 v212, 0, v212
  v_cvt_pk_bf16_f32 v209, v208, v212
  v_lshlrev_b32 v206, 16, v209
  v_and_b32 v212, 0xffff0000, v209
  v_add_f32 v212, 0x3727c5ac, v212
  v_cvt_pk_bf16_f32 v212, v212, v212
  v_lshlrev_b32 v212, 16, v212
  v_sqrt_f32 v212, v212
  s_nop 0
  v_cvt_pk_bf16_f32 v212, v212, v212
  v_lshlrev_b32 v212, 16, v212
  v_rcp_f32 v207, v212
  ds_bpermute_b32 v236, v246, v206 offset:0
  ds_bpermute_b32 v240, v246, v207 offset:0
  ds_bpermute_b32 v237, v246, v206 offset:4
  ds_bpermute_b32 v241, v246, v207 offset:4
  ds_bpermute_b32 v238, v246, v206 offset:8
  ds_bpermute_b32 v242, v246, v207 offset:8
  ds_bpermute_b32 v239, v246, v206 offset:12
  ds_bpermute_b32 v243, v246, v207 offset:12
  s_nop 15
  s_nop 3
L_B_nh3:
  v_fma_f32 v144, -v252, v34, v144
  v_fma_f32 v148, -v252, v38, v148
  v_fma_f32 v145, -v252, v35, v145
  v_fma_f32 v149, -v252, v39, v149
  v_fma_f32 v146, -v252, v36, v146
  v_fma_f32 v150, -v252, v40, v150
  v_fma_f32 v147, -v252, v37, v147
  v_fma_f32 v151, -v252, v41, v151
  v_mul_f32 v144, v144, v253
  v_mul_f32 v148, v148, v253
  v_mul_f32 v145, v145, v253
  v_mul_f32 v149, v149, v253
  v_mul_f32 v146, v146, v253
  v_mul_f32 v150, v150, v253
  v_mul_f32 v147, v147, v253
  v_mul_f32 v151, v151, v253
  v_cvt_pk_bf16_f32 v196, v144, v145
  v_cvt_pk_bf16_f32 v198, v148, v149
  v_cvt_pk_bf16_f32 v197, v146, v147
  v_cvt_pk_bf16_f32 v199, v150, v151
  s_nop 0
  v_mfma_f32_16x16x16_bf16 v[172:175], v[188:189], v[196:197], 0
  v_mfma_f32_16x16x16_bf16 v[180:183], v[190:191], v[198:199], 0
  s_waitcnt vmcnt(2) lgkmcnt(0)
  s_barrier
  s_cmp_lt_u32 s32, 2
  s_cbranch_scc1 L_B_rd01
  ds_read_b128 v[164:167], v200
  ds_read_b128 v[168:171], v200 offset:1024
  s_waitcnt lgkmcnt(0)
  s_branch L_B_rdd
L_B_rd01:
  v_mov_b32 v164, 0
  v_mov_b32 v165, 0
  v_mov_b32 v166, 0
  v_mov_b32 v167, 0
  v_mov_b32 v168, 0
  v_mov_b32 v169, 0
  v_mov_b32 v170, 0
  v_mov_b32 v171, 0
  s_cmp_eq_u32 s30, 0
  s_cbranch_scc1 L_B_rdd
  v_and_b32 v201, 0x370, v1
  s_lshl_b32 s53, s32, 7
  s_add_u32 s53, s53, 147456
  v_add_u32 v201, s53, v201
  v_and_b32 v202, 0x1f0, v1
  s_lshl_b32 s53, s32, 9
  s_add_u32 s53, s53, 147456
  v_add_u32 v202, s53, v202
  ds_read_b128 v[64:67], v201 offset:0
  ds_read_b128 v[68:71], v201 offset:4096
  ds_read_b128 v[72:75], v201 offset:8192
  ds_read_b128 v[76:79], v201 offset:12288
  ds_read_b128 v[80:83], v201 offset:1024
  ds_read_b128 v[84:87], v201 offset:5120
  ds_read_b128 v[88:91], v201 offset:9216
  ds_read_b128 v[92:95], v201 offset:13312
  ds_read_b128 v[96:99], v202 offset:2048
  ds_read_b128 v[100:103], v202 offset:6144
  ds_read_b128 v[104:107], v202 offset:10240
  ds_read_b128 v[108:111], v202 offset:14336
  ds_read_b128 v[112:115], v202 offset:3072
  ds_read_b128 v[116:119], v202 offset:7168
  ds_read_b128 v[120:123], v202 offset:11264
  ds_read_b128 v[124:127], v202 offset:15360
  s_waitcnt lgkmcnt(12)
  v_add_f32 v64, v64, v68
  v_add_f32 v72, v72, v76
  v_add_f32 v65, v65, v69
  v_add_f32 v73, v73, v77
  v_add_f32 v66, v66, v70
  v_add_f32 v74, v74, v78
  v_add_f32 v67, v67, v71
  v_add_f32 v75, v75, v79
  v_add_f32 v64, v64, v72
  v_add_f32 v65, v65, v73
  v_add_f32 v66, v66, v74
  v_add_f32 v67, v67, v75
  s_waitcnt lgkmcnt(8)
  v_add_f32 v80, v80, v84
  v_add_f32 v88, v88, v92
  v_add_f32 v81, v81, v85
  v_add_f32 v89, v89, v93
  v_add_f32 v82, v82, v86
  v_add_f32 v90, v90, v94
  v_add_f32 v83, v83, v87
  v_add_f32 v91, v91, v95
  v_add_f32 v80, v80, v88
  v_add_f32 v81, v81, v89
  v_add_f32 v82, v82, v90
  v_add_f32 v83, v83, v91
  s_waitcnt lgkmcnt(4)
  v_add_f32 v96, v96, v100
  v_add_f32 v104, v104, v108
  v_add_f32 v97, v97, v101
  v_add_f32 v105, v105, v109
  v_add_f32 v98, v98, v102
  v_add_f32 v106, v106, v110
  v_add_f32 v99, v99, v103
  v_add_f32 v107, v107, v111
  v_add_f32 v96, v96, v104
  v_add_f32 v97, v97, v105
  v_add_f32 v98, v98, v106
  v_add_f32 v99, v99, v107
  s_waitcnt lgkmcnt(0)
  v_add_f32 v112, v112, v116
  v_add_f32 v120, v120, v124
  v_add_f32 v113, v113, v117
  v_add_f32 v121, v121, v125
  v_add_f32 v114, v114, v118
  v_add_f32 v122, v122, v126
  v_add_f32 v115, v115, v119
  v_add_f32 v123, v123, v127
  v_add_f32 v112, v112, v120
  v_add_f32 v113, v113, v121
  v_add_f32 v114, v114, v122
  v_add_f32 v115, v115, v123
  v_fma_f32 v64, -v206, v42, v64
  v_fma_f32 v80, -v206, v46, v80
  v_fma_f32 v96, -v236, v50, v96
  v_fma_f32 v112, -v236, v51, v112
  v_fma_f32 v65, -v206, v43, v65
  v_fma_f32 v81, -v206, v47, v81
  v_fma_f32 v97, -v237, v50, v97
  v_fma_f32 v113, -v237, v51, v113
  v_fma_f32 v66, -v206, v44, v66
  v_fma_f32 v82, -v206, v48, v82
  v_fma_f32 v98, -v238, v50, v98
  v_fma_f32 v114, -v238, v51, v114
  v_fma_f32 v67, -v206, v45, v67
  v_fma_f32 v83, -v206, v49, v83
  v_fma_f32 v99, -v239, v50, v99
  v_fma_f32 v115, -v239, v51, v115
  v_mul_f32 v64, v64, v207
  v_mul_f32 v80, v80, v207
  v_mul_f32 v96, v96, v240
  v_mul_f32 v112, v112, v240
  v_mul_f32 v65, v65, v207
  v_mul_f32 v81, v81, v207
  v_mul_f32 v97, v97, v241
  v_mul_f32 v113, v113, v241
  v_mul_f32 v66, v66, v207
  v_mul_f32 v82, v82, v207
  v_mul_f32 v98, v98, v242
  v_mul_f32 v114, v114, v242
  v_mul_f32 v67, v67, v207
  v_mul_f32 v83, v83, v207
  v_mul_f32 v99, v99, v243
  v_mul_f32 v115, v115, v243
  v_cvt_pk_bf16_f32 v164, v64, v65
  v_cvt_pk_bf16_f32 v166, v80, v81
  v_cvt_pk_bf16_f32 v168, v96, v97
  v_cvt_pk_bf16_f32 v170, v112, v113
  v_cvt_pk_bf16_f32 v165, v66, v67
  v_cvt_pk_bf16_f32 v167, v82, v83
  v_cvt_pk_bf16_f32 v169, v98, v99
  v_cvt_pk_bf16_f32 v171, v114, v115
  s_nop 15
  s_nop 3
L_B_rdd:
  v_mfma_f32_16x16x16_bf16 v[176:179], v[164:165], v[196:197], 0
  v_mfma_f32_16x16x16_bf16 v[184:187], v[166:167], v[198:199], 0
  v_mov_b32 v200, v168
  v_mov_b32 v201, v169
  v_mov_b32 v202, v192
  v_mov_b32 v203, v193
  v_mov_b32 v204, v170
  v_mov_b32 v205, v171
  v_mov_b32 v206, v194
  v_mov_b32 v207, v195
  v_cvt_pk_bf16_f32 v208, v172, v173
  v_cvt_pk_bf16_f32 v216, v180, v181
  v_cvt_pk_bf16_f32 v209, v174, v175
  v_cvt_pk_bf16_f32 v217, v182, v183
  v_lshlrev_b32 v172, 16, v208
  v_lshlrev_b32 v180, 16, v216
  v_and_b32 v173, 0xffff0000, v208
  v_and_b32 v181, 0xffff0000, v216
  v_lshlrev_b32 v174, 16, v209
  v_lshlrev_b32 v182, 16, v217
  v_and_b32 v175, 0xffff0000, v209
  v_and_b32 v183, 0xffff0000, v217
  v_cvt_pk_bf16_f32 v210, v176, v177
  v_cvt_pk_bf16_f32 v218, v184, v185
  v_cvt_pk_bf16_f32 v211, v178, v179
  v_cvt_pk_bf16_f32 v219, v186, v187
  v_lshlrev_b32 v176, 16, v210
  v_lshlrev_b32 v184, 16, v218
  v_and_b32 v177, 0xffff0000, v210
  v_and_b32 v185, 0xffff0000, v218
  v_lshlrev_b32 v178, 16, v211
  v_lshlrev_b32 v186, 16, v219
  v_and_b32 v179, 0xffff0000, v211
  v_and_b32 v187, 0xffff0000, v219
  v_add_f32 v172, v172, v56
  v_add_f32 v180, v180, v56
  v_add_f32 v173, v173, v57
  v_add_f32 v181, v181, v57
  v_add_f32 v174, v174, v58
  v_add_f32 v182, v182, v58
  v_add_f32 v175, v175, v59
  v_add_f32 v183, v183, v59
  v_add_f32 v176, v176, v60
  v_add_f32 v184, v184, v60
  v_add_f32 v177, v177, v61
  v_add_f32 v185, v185, v61
  v_add_f32 v178, v178, v62
  v_add_f32 v186, v186, v62
  v_add_f32 v179, v179, v63
  v_add_f32 v187, v187, v63
  v_max_f32 v208, v172, v173
  v_max_f32 v216, v180, v181
  v_max_f32 v209, v174, v175
  v_max_f32 v217, v182, v183
  v_max_f32 v210, v176, v177
  v_max_f32 v218, v184, v185
  v_max_f32 v211, v178, v179
  v_max_f32 v219, v186, v187
  v_max_f32 v208, v208, v209
  v_max_f32 v216, v216, v217
  v_max_f32 v210, v210, v211
  v_max_f32 v218, v218, v219
  v_max_f32 v208, v208, v210
  v_max_f32 v216, v216, v218
  ds_swizzle_b32 v209, v208 offset:0x401f
  ds_swizzle_b32 v217, v216 offset:0x401f
  ds_bpermute_b32 v210, v244, v208
  ds_bpermute_b32 v218, v244, v216
  ds_bpermute_b32 v211, v245, v208
  ds_bpermute_b32 v219, v245, v216
  s_waitcnt lgkmcnt(0)
  v_max_f32 v208, v208, v209
  v_max_f32 v216, v216, v217
  v_max_f32 v210, v210, v211
  v_max_f32 v218, v218, v219
  v_max_f32 v208, v208, v210
  v_max_f32 v216, v216, v218
  v_mul_f32 v208, s61, v208
  v_mul_f32 v216, s61, v216
  v_fma_f32 v172, v172, s61, -v208
  v_fma_f32 v180, v180, s61, -v216
  v_fma_f32 v173, v173, s61, -v208
  v_fma_f32 v181, v181, s61, -v216
  v_fma_f32 v174, v174, s61, -v208
  v_fma_f32 v182, v182, s61, -v216
  v_fma_f32 v175, v175, s61, -v208
  v_fma_f32 v183, v183, s61, -v216
  v_fma_f32 v176, v176, s61, -v208
  v_fma_f32 v184, v184, s61, -v216
  v_fma_f32 v177, v177, s61, -v208
  v_fma_f32 v185, v185, s61, -v216
  v_fma_f32 v178, v178, s61, -v208
  v_fma_f32 v186, v186, s61, -v216
  v_fma_f32 v179, v179, s61, -v208
  v_fma_f32 v187, v187, s61, -v216
  v_exp_f32 v172, v172
  v_exp_f32 v180, v180
  v_exp_f32 v173, v173
  v_exp_f32 v181, v181
  v_exp_f32 v174, v174
  v_exp_f32 v182, v182
  v_exp_f32 v175, v175
  v_exp_f32 v183, v183
  v_exp_f32 v176, v176
  v_exp_f32 v184, v184
  v_exp_f32 v177, v177
  v_exp_f32 v185, v185
  v_exp_f32 v178, v178
  v_exp_f32 v186, v186
  v_exp_f32 v179, v179
  v_exp_f32 v187, v187
  v_add_f32 v208, v172, v173
  v_add_f32 v216, v180, v181
  v_add_f32 v209, v174, v175
  v_add_f32 v217, v182, v183
  v_add_f32 v210, v176, v177
  v_add_f32 v218, v184, v185
  v_add_f32 v211, v178, v179
  v_add_f32 v219, v186, v187
  v_add_f32 v208, v208, v209
  v_add_f32 v216, v216, v217
  v_add_f32 v210, v210, v211
  v_add_f32 v218, v218, v219
  v_add_f32 v208, v208, v210
  v_add_f32 v216, v216, v218
  s_nop 0
  v_mfma_f32_16x16x4_f32 v[212:215], v6, v208, 0
  v_mfma_f32_16x16x4_f32 v[220:223], v6, v216, 0
  s_nop 8
  v_rcp_f32 v212, v212
  v_rcp_f32 v220, v220
  v_mul_f32 v172, v172, v212
  v_mul_f32 v180, v180, v220
  v_mul_f32 v173, v173, v212
  v_mul_f32 v181, v181, v220
  v_mul_f32 v174, v174, v212
  v_mul_f32 v182, v182, v220
  v_mul_f32 v175, v175, v212
  v_mul_f32 v183, v183, v220
  v_mul_f32 v176, v176, v212
  v_mul_f32 v184, v184, v220
  v_mul_f32 v177, v177, v212
  v_mul_f32 v185, v185, v220
  v_mul_f32 v178, v178, v212
  v_mul_f32 v186, v186, v220
  v_mul_f32 v179, v179, v212
  v_mul_f32 v187, v187, v220
  v_cvt_pk_bf16_f32 v208, v176, v177
  v_cvt_pk_bf16_f32 v216, v184, v185
  v_cvt_pk_bf16_f32 v209, v178, v179
  v_cvt_pk_bf16_f32 v217, v186, v187
  v_cvt_pk_bf16_f32 v210, v172, v173
  v_cvt_pk_bf16_f32 v218, v180, v181
  v_cvt_pk_bf16_f32 v211, v174, v175
  v_cvt_pk_bf16_f32 v219, v182, v183
  s_nop 0
  v_mfma_f32_16x16x32_bf16 v[172:175], v[200:203], v[208:211], 0
  v_mfma_f32_16x16x32_bf16 v[180:183], v[204:207], v[216:219], 0
  s_nop 6
  v_cvt_pk_bf16_f32 v152, v172, v173
  v_cvt_pk_bf16_f32 v153, v174, v175
  v_cvt_pk_bf16_f32 v154, v180, v181
  v_cvt_pk_bf16_f32 v155, v182, v183
  s_cmp_eq_u32 s73, 0
  s_cbranch_scc1 L_ds_47
  buffer_store_dwordx4 v[152:155], v1, s[4:7], s42 offen
  s_branch L_dd_48
L_ds_47:
  buffer_store_dwordx4 v[152:155], v1, s[4:7], s42 offen sc1
L_dd_48:
  s_cmp_eq_u32 s39, 3
  s_cbranch_scc1 L_B_nopf
  s_mul_i32 s53, s32, 12288
  s_add_u32 s52, s67, s53
  s_add_u32 s53, s53, 0
  s_mov_b32 m0, s53
  s_nop 0
  buffer_load_dwordx4 v1, s[4:7], s52 offen offset:0  lds
  buffer_load_dwordx4 v1, s[4:7], s52 offen offset:1024  lds
  buffer_load_dwordx4 v1, s[4:7], s52 offen offset:2048  lds
  buffer_load_dwordx4 v1, s[4:7], s52 offen offset:3072  lds
  s_add_u32 s52, s52, 4096
  s_add_u32 s53, s53, 4096
  s_mov_b32 m0, s53
  s_nop 0
  buffer_load_dwordx4 v1, s[4:7], s52 offen offset:0  lds
  buffer_load_dwordx4 v1, s[4:7], s52 offen offset:1024  lds
  buffer_load_dwordx4 v1, s[4:7], s52 offen offset:2048  lds
  buffer_load_dwordx4 v1, s[4:7], s52 offen offset:3072  lds
  s_add_u32 s52, s52, 4096
  s_add_u32 s53, s53, 4096
  s_mov_b32 m0, s53
  s_nop 0
  buffer_load_dwordx4 v1, s[4:7], s52 offen offset:0  lds
  buffer_load_dwordx4 v1, s[4:7], s52 offen offset:1024  lds
  buffer_load_dwordx4 v1, s[4:7], s52 offen offset:2048  lds
  buffer_load_dwordx4 v1, s[4:7], s52 offen offset:3072  lds
L_B_nopf:
  s_nop 15
  s_nop 3
L_WO:
  buffer_load_dwordx4 v[64:67], v1, s[4:7], s43 offen offset:0 sc1
  buffer_load_dwordx4 v[68:71], v1, s[4:7], s43 offen offset:1024 sc1
  buffer_load_dwordx4 v[72:75], v1, s[4:7], s43 offen offset:2048 sc1
  buffer_load_dwordx4 v[76:79], v1, s[4:7], s43 offen offset:3072 sc1
  s_add_u32 s58, s43, 4096
  buffer_load_dwordx4 v[80:83], v1, s[4:7], s58 offen offset:0 sc1
  buffer_load_dwordx4 v[84:87], v1, s[4:7], s58 offen offset:1024 sc1
  buffer_load_dwordx4 v[88:91], v1, s[4:7], s58 offen offset:2048 sc1
  buffer_load_dwordx4 v[92:95], v1, s[4:7], s58 offen offset:3072 sc1
  v_lshlrev_b32 v200, 16, v52
  v_and_b32 v201, 0xffff0000, v52
  v_lshlrev_b32 v202, 16, v53
  v_and_b32 v203, 0xffff0000, v53
  v_lshlrev_b32 v204, 16, v54
  v_and_b32 v205, 0xffff0000, v54
  v_lshlrev_b32 v206, 16, v55
  v_and_b32 v207, 0xffff0000, v55
  ds_read_b128 v[152:155], v3 offset:0
  ds_read_b128 v[156:159], v3 offset:1024
  ds_read_b128 v[160:163], v3 offset:2048
  ds_read_b128 v[164:167], v3 offset:3072
  ds_read_b128 v[168:171], v3 offset:4096
  ds_read_b128 v[172:175], v3 offset:5120
  ds_read_b128 v[176:179], v3 offset:6144
  ds_read_b128 v[180:183], v3 offset:7168
  s_waitcnt vmcnt(4)
  s_mov_b32 s56, 0
L_chk_49:
  v_max3_u32 v255, v64, v65, v66
  v_max3_u32 v255, v255, v67, v68
  v_max3_u32 v255, v255, v69, v70
  v_max3_u32 v255, v255, v71, v72
  v_max3_u32 v255, v255, v73, v74
  v_max3_u32 v255, v255, v75, v76
  v_max3_u32 v255, v255, v77, v78
  v_max_u32 v255, v255, v79
  v_cmp_eq_u32 vcc, -1, v255
  s_cbranch_vccnz L_rt_50
L_cd_51:
  s_add_u32 s58, s43, 8192
  buffer_load_dwordx4 v[96:99], v1, s[4:7], s58 offen offset:0 sc1
  buffer_load_dwordx4 v[100:103], v1, s[4:7], s58 offen offset:1024 sc1
  buffer_load_dwordx4 v[104:107], v1, s[4:7], s58 offen offset:2048 sc1
  buffer_load_dwordx4 v[108:111], v1, s[4:7], s58 offen offset:3072 sc1
  s_waitcnt lgkmcnt(7)
  v_mfma_f32_16x16x32_bf16 v[128:131], v[152:155], v[64:67], 0
  ds_read_b128 v[184:187], v3 offset:8192
  s_waitcnt lgkmcnt(7)
  v_mfma_f32_16x16x32_bf16 v[132:135], v[156:159], v[64:67], 0
  ds_read_b128 v[152:155], v3 offset:9216
  s_waitcnt lgkmcnt(7)
  v_mfma_f32_16x16x32_bf16 v[128:131], v[160:163], v[68:71], v[128:131]
  ds_read_b128 v[156:159], v3 offset:10240
  s_waitcnt lgkmcnt(7)
  v_mfma_f32_16x16x32_bf16 v[132:135], v[164:167], v[68:71], v[132:135]
  ds_read_b128 v[160:163], v3 offset:11264
  s_waitcnt lgkmcnt(7)
  v_mfma_f32_16x16x32_bf16 v[128:131], v[168:171], v[72:75], v[128:131]
  ds_read_b128 v[164:167], v3 offset:12288
  s_waitcnt lgkmcnt(7)
  v_mfma_f32_16x16x32_bf16 v[132:135], v[172:175], v[72:75], v[132:135]
  ds_read_b128 v[168:171], v3 offset:13312
  s_waitcnt lgkmcnt(7)
  v_mfma_f32_16x16x32_bf16 v[128:131], v[176:179], v[76:79], v[128:131]
  ds_read_b128 v[172:175], v3 offset:14336
  s_waitcnt lgkmcnt(7)
  v_mfma_f32_16x16x32_bf16 v[132:135], v[180:183], v[76:79], v[132:135]
  ds_read_b128 v[176:179], v3 offset:15360
  s_waitcnt vmcnt(4)
  s_mov_b32 s56, 0
L_chk_52:
  v_max3_u32 v255, v80, v81, v82
  v_max3_u32 v255, v255, v83, v84
  v_max3_u32 v255, v255, v85, v86
  v_max3_u32 v255, v255, v87, v88
  v_max3_u32 v255, v255, v89, v90
  v_max3_u32 v255, v255, v91, v92
  v_max3_u32 v255, v255, v93, v94
  v_max_u32 v255, v255, v95
  v_cmp_eq_u32 vcc, -1, v255
  s_cbranch_vccnz L_rt_53
L_cd_54:
  s_add_u32 s58, s43, 12288
  buffer_load_dwordx4 v[112:115], v1, s[4:7], s58 offen offset:0 sc1
  buffer_load_dwordx4 v[116:119], v1, s[4:7], s58 offen offset:1024 sc1
  buffer_load_dwordx4 v[120:123], v1, s[4:7], s58 offen offset:2048 sc1
  buffer_load_dwordx4 v[124:127], v1, s[4:7], s58 offen offset:3072 sc1
  s_waitcnt lgkmcnt(7)
  v_mfma_f32_16x16x32_bf16 v[128:131], v[184:187], v[80:83], v[128:131]
  ds_read_b128 v[180:183], v3 offset:16384
  s_waitcnt lgkmcnt(7)
  v_mfma_f32_16x16x32_bf16 v[132:135], v[152:155], v[80:83], v[132:135]
  ds_read_b128 v[184:187], v3 offset:17408
  s_waitcnt lgkmcnt(7)
  v_mfma_f32_16x16x32_bf16 v[128:131], v[156:159], v[84:87], v[128:131]
  ds_read_b128 v[152:155], v3 offset:18432
  s_waitcnt lgkmcnt(7)
  v_mfma_f32_16x16x32_bf16 v[132:135], v[160:163], v[84:87], v[132:135]
  ds_read_b128 v[156:159], v3 offset:19456
  s_waitcnt lgkmcnt(7)
  v_mfma_f32_16x16x32_bf16 v[128:131], v[164:167], v[88:91], v[128:131]
  ds_read_b128 v[160:163], v3 offset:20480
  s_waitcnt lgkmcnt(7)
  v_mfma_f32_16x16x32_bf16 v[132:135], v[168:171], v[88:91], v[132:135]
  ds_read_b128 v[164:167], v3 offset:21504
  s_waitcnt lgkmcnt(7)
  v_mfma_f32_16x16x32_bf16 v[128:131], v[172:175], v[92:95], v[128:131]
  ds_read_b128 v[168:171], v3 offset:22528
  s_waitcnt lgkmcnt(7)
  v_mfma_f32_16x16x32_bf16 v[132:135], v[176:179], v[92:95], v[132:135]
  ds_read_b128 v[172:175], v3 offset:23552
  s_waitcnt vmcnt(4)
  s_mov_b32 s56, 0
L_chk_55:
  v_max3_u32 v255, v96, v97, v98
  v_max3_u32 v255, v255, v99, v100
  v_max3_u32 v255, v255, v101, v102
  v_max3_u32 v255, v255, v103, v104
  v_max3_u32 v255, v255, v105, v106
  v_max3_u32 v255, v255, v107, v108
  v_max3_u32 v255, v255, v109, v110
  v_max_u32 v255, v255, v111
  v_cmp_eq_u32 vcc, -1, v255
  s_cbranch_vccnz L_rt_56
L_cd_57:
  s_waitcnt lgkmcnt(7)
  v_mfma_f32_16x16x32_bf16 v[128:131], v[180:183], v[96:99], v[128:131]
  ds_read_b128 v[176:179], v3 offset:24576
  s_waitcnt lgkmcnt(7)
  v_mfma_f32_16x16x32_bf16 v[132:135], v[184:187], v[96:99], v[132:135]
  ds_read_b128 v[180:183], v3 offset:25600
  s_waitcnt lgkmcnt(7)
  v_mfma_f32_16x16x32_bf16 v[128:131], v[152:155], v[100:103], v[128:131]
  ds_read_b128 v[184:187], v3 offset:26624
  s_waitcnt lgkmcnt(7)
  v_mfma_f32_16x16x32_bf16 v[132:135], v[156:159], v[100:103], v[132:135]
  ds_read_b128 v[152:155], v3 offset:27648
  s_waitcnt lgkmcnt(7)
  v_mfma_f32_16x16x32_bf16 v[128:131], v[160:163], v[104:107], v[128:131]
  ds_read_b128 v[156:159], v3 offset:28672
  s_waitcnt lgkmcnt(7)
  v_mfma_f32_16x16x32_bf16 v[132:135], v[164:167], v[104:107], v[132:135]
  ds_read_b128 v[160:163], v3 offset:29696
  s_waitcnt lgkmcnt(7)
  v_mfma_f32_16x16x32_bf16 v[128:131], v[168:171], v[108:111], v[128:131]
  ds_read_b128 v[164:167], v3 offset:30720
  s_waitcnt lgkmcnt(7)
  v_mfma_f32_16x16x32_bf16 v[132:135], v[172:175], v[108:111], v[132:135]
  ds_read_b128 v[168:171], v3 offset:31744
  s_waitcnt vmcnt(0)
  s_mov_b32 s56, 0
L_chk_58:
  v_max3_u32 v255, v112, v113, v114
  v_max3_u32 v255, v255, v115, v116
  v_max3_u32 v255, v255, v117, v118
  v_max3_u32 v255, v255, v119, v120
  v_max3_u32 v255, v255, v121, v122
  v_max3_u32 v255, v255, v123, v124
  v_max3_u32 v255, v255, v125, v126
  v_max_u32 v255, v255, v127
  v_cmp_eq_u32 vcc, -1, v255
  s_cbranch_vccnz L_rt_59
L_cd_60:
  s_mul_i32 s53, s32, 4096
  s_add_u32 s52, s68, s53
  s_mov_b64 exec, 0xffffffff
  buffer_load_dword v233, v15, s[4:7], s52 offen
  s_mov_b64 exec, -1
  s_waitcnt lgkmcnt(7)
  v_mfma_f32_16x16x32_bf16 v[128:131], v[176:179], v[112:115], v[128:131]
  s_waitcnt lgkmcnt(6)
  v_mfma_f32_16x16x32_bf16 v[132:135], v[180:183], v[112:115], v[132:135]
  s_waitcnt lgkmcnt(5)
  v_mfma_f32_16x16x32_bf16 v[128:131], v[184:187], v[116:119], v[128:131]
  s_waitcnt lgkmcnt(4)
  v_mfma_f32_16x16x32_bf16 v[132:135], v[152:155], v[116:119], v[132:135]
  s_waitcnt lgkmcnt(3)
  v_mfma_f32_16x16x32_bf16 v[128:131], v[156:159], v[120:123], v[128:131]
  s_waitcnt lgkmcnt(2)
  v_mfma_f32_16x16x32_bf16 v[132:135], v[160:163], v[120:123], v[132:135]
  s_waitcnt lgkmcnt(1)
  v_mfma_f32_16x16x32_bf16 v[128:131], v[164:167], v[124:127], v[128:131]
  s_waitcnt lgkmcnt(0)
  v_mfma_f32_16x16x32_bf16 v[132:135], v[168:171], v[124:127], v[132:135]
  s_nop 5
  v_cvt_pk_bf16_f32 v152, v128, v129
  s_nop 0
  v_cvt_pk_bf16_f32 v154, v132, v133
  v_cvt_pk_bf16_f32 v153, v130, v131
  v_cvt_pk_bf16_f32 v155, v134, v135
  v_lshlrev_b32 v128, 16, v152
  v_lshlrev_b32 v132, 16, v154
  v_and_b32 v129, 0xffff0000, v152
  v_and_b32 v133, 0xffff0000, v154
  v_lshlrev_b32 v130, 16, v153
  v_lshlrev_b32 v134, 16, v155
  v_and_b32 v131, 0xffff0000, v153
  v_and_b32 v135, 0xffff0000, v155
  v_add_f32 v128, v128, v200
  v_add_f32 v129, v129, v201
  v_add_f32 v130, v130, v202
  v_add_f32 v131, v131, v203
  v_add_f32 v132, v132, v204
  v_add_f32 v133, v133, v205
  v_add_f32 v134, v134, v206
  v_add_f32 v135, v135, v207
  v_cvt_pk_bf16_f32 v52, v128, v129
  v_cvt_pk_bf16_f32 v53, v130, v131
  v_cvt_pk_bf16_f32 v54, v132, v133
  v_cvt_pk_bf16_f32 v55, v134, v135
  s_cmp_eq_u32 s39, 3
  s_cbranch_scc1 L_final
  s_cmp_eq_u32 s73, 0
  s_cbranch_scc1 L_ds_61
  buffer_store_dwordx4 v[52:55], v1, s[4:7], s44 offen
  s_branch L_dd_62
L_ds_61:
  buffer_store_dwordx4 v[52:55], v1, s[4:7], s44 offen sc1
L_dd_62:
  v_dot2_f32_bf16 v152, v52, v248, 0
  v_dot2_f32_bf16 v153, v52, v52, 0
  v_dot2_f32_bf16 v152, v53, v248, v152
  v_dot2_f32_bf16 v153, v53, v53, v153
  v_dot2_f32_bf16 v152, v54, v248, v152
  v_dot2_f32_bf16 v153, v54, v54, v153
  v_dot2_f32_bf16 v152, v55, v248, v152
  v_dot2_f32_bf16 v153, v55, v55, v153
  s_nop 1
  v_mfma_f32_16x16x4_f32 v[156:159], v6, v152, 0
  v_mfma_f32_16x16x4_f32 v[160:163], v6, v153, 0
  s_nop 9
  v_mov_b32 v157, v160
  s_mov_b64 exec, 0xffff
  s_cmp_eq_u32 s73, 0
  s_cbranch_scc1 L_ds_63
  buffer_store_dwordx2 v[156:157], v1, s[4:7], s45 offen
  s_branch L_dd_64
L_ds_63:
  buffer_store_dwordx2 v[156:157], v1, s[4:7], s45 offen sc1
L_dd_64:
  s_mov_b64 exec, -1
  v_mov_b32 v4, v156
  v_mov_b32 v5, v157
  s_add_u32 s39, s39, 1
  s_branch L_layer
  s_nop 15
  s_nop 3
L_final:
  v_and_b32 v200, 15, v7
  v_lshlrev_b32 v200, 11, v200
  v_lshrrev_b32 v201, 1, v246
  v_add_u32 v200, v200, v201
  s_lshr_b32 s53, s33, 1
  s_lshl_b32 s53, s53, 5
  s_and_b32 s54, s33, 1
  s_add_u32 s53, s53, s54
  s_lshl_b32 s53, s53, 10
  s_lshl_b32 s54, s31, 6
  s_add_u32 s53, s53, s54
  buffer_store_dwordx2 v[52:53], v200, s[8:11], s53 offen
  buffer_store_dwordx2 v[54:55], v200, s[8:11], s53 offen offset:32
L_km_end:
  s_endpgm
  s_nop 15
  s_nop 3
L_rt_2:
  s_add_u32 s90, s90, 1
  s_add_u32 s56, s56, 1
  s_cmp_gt_u32 s56, 0x40000
  s_cbranch_scc1 L_cd_3
  s_sleep 1
  s_mov_b64 exec, 0xffff
  buffer_load_dword v254, v235, s[4:7], s40 offen offset:1020 sc1
  s_waitcnt vmcnt(0)
  v_cmp_eq_u32 vcc, -1, v254
  s_mov_b64 exec, -1
  s_cbranch_vccnz L_rt_2
  buffer_load_dwordx4 v[64:67], v1, s[4:7], s40 offen offset:0 sc1
  buffer_load_dwordx4 v[68:71], v1, s[4:7], s40 offen offset:1024 sc1
  buffer_load_dwordx4 v[72:75], v1, s[4:7], s40 offen offset:2048 sc1
  buffer_load_dwordx4 v[76:79], v1, s[4:7], s40 offen offset:3072 sc1
  s_add_u32 s58, s40, 4096
  buffer_load_dwordx4 v[80:83], v1, s[4:7], s58 offen offset:0 sc1
  buffer_load_dwordx4 v[84:87], v1, s[4:7], s58 offen offset:1024 sc1
  buffer_load_dwordx4 v[88:91], v1, s[4:7], s58 offen offset:2048 sc1
  buffer_load_dwordx4 v[92:95], v1, s[4:7], s58 offen offset:3072 sc1
  s_waitcnt vmcnt(0)
  s_branch L_chk_1
  s_nop 15
  s_nop 3
L_rt_5:
  s_add_u32 s90, s90, 1
  s_add_u32 s56, s56, 1
  s_cmp_gt_u32 s56, 0x40000
  s_cbranch_scc1 L_cd_6
  s_sleep 1
  s_mov_b64 exec, 0xffff
  buffer_load_dword v254, v235, s[4:7], s40 offen offset:1020 sc1
  s_waitcnt vmcnt(0)
  v_cmp_eq_u32 vcc, -1, v254
  s_mov_b64 exec, -1
  s_cbranch_vccnz L_rt_5
  s_add_u32 s58, s40, 4096
  buffer_load_dwordx4 v[80:83], v1, s[4:7], s58 offen offset:0 sc1
  buffer_load_dwordx4 v[84:87], v1, s[4:7], s58 offen offset:1024 sc1
  buffer_load_dwordx4 v[88:91], v1, s[4:7], s58 offen offset:2048 sc1
  buffer_load_dwordx4 v[92:95], v1, s[4:7], s58 offen offset:3072 sc1
  s_add_u32 s58, s40, 8192
  buffer_load_dwordx4 v[96:99], v1, s[4:7], s58 offen offset:0 sc1
  buffer_load_dwordx4 v[100:103], v1, s[4:7], s58 offen offset:1024 sc1
  buffer_load_dwordx4 v[104:107], v1, s[4:7], s58 offen offset:2048 sc1
  buffer_load_dwordx4 v[108:111], v1, s[4:7], s58 offen offset:3072 sc1
  s_waitcnt vmcnt(0)
  s_branch L_chk_4
  s_nop 15
  s_nop 3
L_rt_8:
  s_add_u32 s90, s90, 1
  s_add_u32 s56, s56, 1
  s_cmp_gt_u32 s56, 0x40000
  s_cbranch_scc1 L_cd_9
  s_sleep 1
  s_mov_b64 exec, 0xffff
  buffer_load_dword v254, v235, s[4:7], s40 offen offset:1020 sc1
  s_waitcnt vmcnt(0)
  v_cmp_eq_u32 vcc, -1, v254
  s_mov_b64 exec, -1
  s_cbranch_vccnz L_rt_8
  s_add_u32 s58, s40, 8192
  buffer_load_dwordx4 v[96:99], v1, s[4:7], s58 offen offset:0 sc1
  buffer_load_dwordx4 v[100:103], v1, s[4:7], s58 offen offset:1024 sc1
  buffer_load_dwordx4 v[104:107], v1, s[4:7], s58 offen offset:2048 sc1
  buffer_load_dwordx4 v[108:111], v1, s[4:7], s58 offen offset:3072 sc1
  s_add_u32 s58, s40, 12288
  buffer_load_dwordx4 v[112:115], v1, s[4:7], s58 offen offset:0 sc1
  buffer_load_dwordx4 v[116:119], v1, s[4:7], s58 offen offset:1024 sc1
  buffer_load_dwordx4 v[120:123], v1, s[4:7], s58 offen offset:2048 sc1
  buffer_load_dwordx4 v[124:127], v1, s[4:7], s58 offen offset:3072 sc1
  s_waitcnt vmcnt(0)
  s_branch L_chk_7
  s_nop 15
  s_nop 3
L_rt_11:
  s_add_u32 s90, s90, 1
  s_add_u32 s56, s56, 1
  s_cmp_gt_u32 s56, 0x40000
  s_cbranch_scc1 L_cd_12
  s_sleep 1
  s_mov_b64 exec, 0xffff
  buffer_load_dword v254, v235, s[4:7], s40 offen offset:1020 sc1
  s_waitcnt vmcnt(0)
  v_cmp_eq_u32 vcc, -1, v254
  s_mov_b64 exec, -1
  s_cbranch_vccnz L_rt_11
  s_add_u32 s58, s40, 12288
  buffer_load_dwordx4 v[112:115], v1, s[4:7], s58 offen offset:0 sc1
  buffer_load_dwordx4 v[116:119], v1, s[4:7], s58 offen offset:1024 sc1
  buffer_load_dwordx4 v[120:123], v1, s[4:7], s58 offen offset:2048 sc1
  buffer_load_dwordx4 v[124:127], v1, s[4:7], s58 offen offset:3072 sc1
  s_waitcnt vmcnt(0)
  s_branch L_chk_10
  s_nop 15
  s_nop 3
L_rt_14:
  s_add_u32 s90, s90, 1
  s_add_u32 s56, s56, 1
  s_cmp_gt_u32 s56, 0x40000
  s_cbranch_scc1 L_cd_15
  s_sleep 1
  buffer_load_dwordx4 v[224:227], v247, s[4:7], s41 offen sc1
  buffer_load_dwordx4 v[228:231], v247, s[4:7], s41 offen offset:256 sc1
  s_waitcnt vmcnt(0)
  s_branch L_chk_13
  s_nop 15
  s_nop 3
L_rt_17:
  s_add_u32 s90, s90, 1
  s_add_u32 s56, s56, 1
  s_cmp_gt_u32 s56, 0x40000
  s_cbranch_scc1 L_cd_18
  s_sleep 1
  s_add_u32 s58, s57, 4096
  buffer_load_dwordx4 v[64:67], v1, s[4:7], s57 offen offset:0 sc1
  buffer_load_dwordx4 v[68:71], v1, s[4:7], s57 offen offset:1024 sc1
  buffer_load_dwordx4 v[72:75], v1, s[4:7], s57 offen offset:2048 sc1
  buffer_load_dwordx4 v[76:79], v1, s[4:7], s57 offen offset:3072 sc1
  buffer_load_dwordx4 v[80:83], v1, s[4:7], s58 offen offset:0 sc1
  buffer_load_dwordx4 v[84:87], v1, s[4:7], s58 offen offset:1024 sc1
  buffer_load_dwordx4 v[88:91], v1, s[4:7], s58 offen offset:2048 sc1
  buffer_load_dwordx4 v[92:95], v1, s[4:7], s58 offen offset:3072 sc1
  s_waitcnt vmcnt(0)
  s_branch L_chk_16
  s_nop 15
  s_nop 3
L_rt_20:
  s_add_u32 s90, s90, 1
  s_add_u32 s56, s56, 1
  s_cmp_gt_u32 s56, 0x40000
  s_cbranch_scc1 L_cd_21
  s_sleep 1
  buffer_load_dwordx4 v[96:99], v1, s[4:7], s50 offen offset:0 sc1
  buffer_load_dwordx4 v[100:103], v1, s[4:7], s50 offen offset:1024 sc1
  buffer_load_dwordx4 v[104:107], v1, s[4:7], s50 offen offset:2048 sc1
  buffer_load_dwordx4 v[108:111], v1, s[4:7], s50 offen offset:3072 sc1
  s_waitcnt vmcnt(0)
  s_branch L_chk_19
  s_nop 15
  s_nop 3
L_rt_27:
  s_add_u32 s90, s90, 1
  s_add_u32 s56, s56, 1
  s_cmp_gt_u32 s56, 0x40000
  s_cbranch_scc1 L_cd_28
  s_sleep 1
  s_mov_b64 exec, 0xffff
  buffer_load_dword v254, v235, s[4:7], s40 offen offset:1020 sc1
  s_waitcnt vmcnt(0)
  v_cmp_eq_u32 vcc, -1, v254
  s_mov_b64 exec, -1
  s_cbranch_vccnz L_rt_27
  buffer_load_dwordx4 v[64:67], v1, s[4:7], s40 offen offset:0 sc1
  buffer_load_dwordx4 v[68:71], v1, s[4:7], s40 offen offset:1024 sc1
  buffer_load_dwordx4 v[72:75], v1, s[4:7], s40 offen offset:2048 sc1
  buffer_load_dwordx4 v[76:79], v1, s[4:7], s40 offen offset:3072 sc1
  s_add_u32 s58, s40, 4096
  buffer_load_dwordx4 v[80:83], v1, s[4:7], s58 offen offset:0 sc1
  buffer_load_dwordx4 v[84:87], v1, s[4:7], s58 offen offset:1024 sc1
  buffer_load_dwordx4 v[88:91], v1, s[4:7], s58 offen offset:2048 sc1
  buffer_load_dwordx4 v[92:95], v1, s[4:7], s58 offen offset:3072 sc1
  s_waitcnt vmcnt(0)
  s_branch L_chk_26
  s_nop 15
  s_nop 3
L_rt_30:
  s_add_u32 s90, s90, 1
  s_add_u32 s56, s56, 1
  s_cmp_gt_u32 s56, 0x40000
  s_cbranch_scc1 L_cd_31
  s_sleep 1
  s_mov_b64 exec, 0xffff
  buffer_load_dword v254, v235, s[4:7], s40 offen offset:1020 sc1
  s_waitcnt vmcnt(0)
  v_cmp_eq_u32 vcc, -1, v254
  s_mov_b64 exec, -1
  s_cbranch_vccnz L_rt_30
  s_add_u32 s58, s40, 4096
  buffer_load_dwordx4 v[80:83], v1, s[4:7], s58 offen offset:0 sc1
  buffer_load_dwordx4 v[84:87], v1, s[4:7], s58 offen offset:1024 sc1
  buffer_load_dwordx4 v[88:91], v1, s[4:7], s58 offen offset:2048 sc1
  buffer_load_dwordx4 v[92:95], v1, s[4:7], s58 offen offset:3072 sc1
  s_add_u32 s58, s40, 8192
  buffer_load_dwordx4 v[96:99], v1, s[4:7], s58 offen offset:0 sc1
  buffer_load_dwordx4 v[100:103], v1, s[4:7], s58 offen offset:1024 sc1
  buffer_load_dwordx4 v[104:107], v1, s[4:7], s58 offen offset:2048 sc1
  buffer_load_dwordx4 v[108:111], v1, s[4:7], s58 offen offset:3072 sc1
  s_waitcnt vmcnt(0)
  s_branch L_chk_29
  s_nop 15
  s_nop 3
L_rt_33:
  s_add_u32 s90, s90, 1
  s_add_u32 s56, s56, 1
  s_cmp_gt_u32 s56, 0x40000
  s_cbranch_scc1 L_cd_34
  s_sleep 1
  s_mov_b64 exec, 0xffff
  buffer_load_dword v254, v235, s[4:7], s40 offen offset:1020 sc1
  s_waitcnt vmcnt(0)
  v_cmp_eq_u32 vcc, -1, v254
  s_mov_b64 exec, -1
  s_cbranch_vccnz L_rt_33
  s_add_u32 s58, s40, 8192
  buffer_load_dwordx4 v[96:99], v1, s[4:7], s58 offen offset:0 sc1
  buffer_load_dwordx4 v[100:103], v1, s[4:7], s58 offen offset:1024 sc1
  buffer_load_dwordx4 v[104:107], v1, s[4:7], s58 offen offset:2048 sc1
  buffer_load_dwordx4 v[108:111], v1, s[4:7], s58 offen offset:3072 sc1
  s_add_u32 s58, s40, 12288
  buffer_load_dwordx4 v[112:115], v1, s[4:7], s58 offen offset:0 sc1
  buffer_load_dwordx4 v[116:119], v1, s[4:7], s58 offen offset:1024 sc1
  buffer_load_dwordx4 v[120:123], v1, s[4:7], s58 offen offset:2048 sc1
  buffer_load_dwordx4 v[124:127], v1, s[4:7], s58 offen offset:3072 sc1
  s_waitcnt vmcnt(0)
  s_branch L_chk_32
  s_nop 15
  s_nop 3
L_rt_36:
  s_add_u32 s90, s90, 1
  s_add_u32 s56, s56, 1
  s_cmp_gt_u32 s56, 0x40000
  s_cbranch_scc1 L_cd_37
  s_sleep 1
  s_mov_b64 exec, 0xffff
  buffer_load_dword v254, v235, s[4:7], s40 offen offset:1020 sc1
  s_waitcnt vmcnt(0)
  v_cmp_eq_u32 vcc, -1, v254
  s_mov_b64 exec, -1
  s_cbranch_vccnz L_rt_36
  s_add_u32 s58, s40, 12288
  buffer_load_dwordx4 v[112:115], v1, s[4:7], s58 offen offset:0 sc1
  buffer_load_dwordx4 v[116:119], v1, s[4:7], s58 offen offset:1024 sc1
  buffer_load_dwordx4 v[120:123], v1, s[4:7], s58 offen offset:2048 sc1
  buffer_load_dwordx4 v[124:127], v1, s[4:7], s58 offen offset:3072 sc1
  s_waitcnt vmcnt(0)
  s_branch L_chk_35
  s_nop 15
  s_nop 3
L_rt_39:
  s_add_u32 s90, s90, 1
  s_add_u32 s56, s56, 1
  s_cmp_gt_u32 s56, 0x40000
  s_cbranch_scc1 L_cd_40
  s_sleep 1
  buffer_load_dwordx4 v[224:227], v247, s[4:7], s41 offen sc1
  buffer_load_dwordx4 v[228:231], v247, s[4:7], s41 offen offset:256 sc1
  s_waitcnt vmcnt(0)
  s_branch L_chk_38
  s_nop 15
  s_nop 3
L_rt_42:
  s_add_u32 s90, s90, 1
  s_add_u32 s56, s56, 1
  s_cmp_gt_u32 s56, 0x40000
  s_cbranch_scc1 L_cd_43
  s_sleep 1
  buffer_load_dwordx4 v[208:211], v201, s[4:7], s54 offen offset:0 sc1
  buffer_load_dwordx4 v[212:215], v201, s[4:7], s54 offen offset:1024 sc1
  buffer_load_dwordx4 v[216:219], v201, s[4:7], s54 offen offset:2048 sc1
  buffer_load_dwordx4 v[220:223], v201, s[4:7], s54 offen offset:3072 sc1
  s_waitcnt vmcnt(0)
  s_branch L_chk_41
  s_nop 15
  s_nop 3
L_rt_45:
  s_add_u32 s90, s90, 1
  s_add_u32 s56, s56, 1
  s_cmp_gt_u32 s56, 0x40000
  s_cbranch_scc1 L_cd_46
  s_sleep 1
  buffer_load_dwordx4 v[224:227], v202, s[4:7], s55 offen sc1
  buffer_load_dwordx4 v[228:231], v202, s[4:7], s55 offen offset:256 sc1
  s_waitcnt vmcnt(0)
  s_branch L_chk_44
  s_nop 15
  s_nop 3
L_rt_50:
  s_add_u32 s90, s90, 1
  s_add_u32 s56, s56, 1
  s_cmp_gt_u32 s56, 0x40000
  s_cbranch_scc1 L_cd_51
  s_sleep 1
  s_mov_b64 exec, 0xffff
  buffer_load_dword v254, v235, s[4:7], s43 offen offset:1020 sc1
  s_waitcnt vmcnt(0)
  v_cmp_eq_u32 vcc, -1, v254
  s_mov_b64 exec, -1
  s_cbranch_vccnz L_rt_50
  buffer_load_dwordx4 v[64:67], v1, s[4:7], s43 offen offset:0 sc1
  buffer_load_dwordx4 v[68:71], v1, s[4:7], s43 offen offset:1024 sc1
  buffer_load_dwordx4 v[72:75], v1, s[4:7], s43 offen offset:2048 sc1
  buffer_load_dwordx4 v[76:79], v1, s[4:7], s43 offen offset:3072 sc1
  s_add_u32 s58, s43, 4096
  buffer_load_dwordx4 v[80:83], v1, s[4:7], s58 offen offset:0 sc1
  buffer_load_dwordx4 v[84:87], v1, s[4:7], s58 offen offset:1024 sc1
  buffer_load_dwordx4 v[88:91], v1, s[4:7], s58 offen offset:2048 sc1
  buffer_load_dwordx4 v[92:95], v1, s[4:7], s58 offen offset:3072 sc1
  s_waitcnt vmcnt(0)
  s_branch L_chk_49
  s_nop 15
  s_nop 3
L_rt_53:
  s_add_u32 s90, s90, 1
  s_add_u32 s56, s56, 1
  s_cmp_gt_u32 s56, 0x40000
  s_cbranch_scc1 L_cd_54
  s_sleep 1
  s_mov_b64 exec, 0xffff
  buffer_load_dword v254, v235, s[4:7], s43 offen offset:1020 sc1
  s_waitcnt vmcnt(0)
  v_cmp_eq_u32 vcc, -1, v254
  s_mov_b64 exec, -1
  s_cbranch_vccnz L_rt_53
  s_add_u32 s58, s43, 4096
  buffer_load_dwordx4 v[80:83], v1, s[4:7], s58 offen offset:0 sc1
  buffer_load_dwordx4 v[84:87], v1, s[4:7], s58 offen offset:1024 sc1
  buffer_load_dwordx4 v[88:91], v1, s[4:7], s58 offen offset:2048 sc1
  buffer_load_dwordx4 v[92:95], v1, s[4:7], s58 offen offset:3072 sc1
  s_add_u32 s58, s43, 8192
  buffer_load_dwordx4 v[96:99], v1, s[4:7], s58 offen offset:0 sc1
  buffer_load_dwordx4 v[100:103], v1, s[4:7], s58 offen offset:1024 sc1
  buffer_load_dwordx4 v[104:107], v1, s[4:7], s58 offen offset:2048 sc1
  buffer_load_dwordx4 v[108:111], v1, s[4:7], s58 offen offset:3072 sc1
  s_waitcnt vmcnt(0)
  s_branch L_chk_52
  s_nop 15
  s_nop 3
L_rt_56:
  s_add_u32 s90, s90, 1
  s_add_u32 s56, s56, 1
  s_cmp_gt_u32 s56, 0x40000
  s_cbranch_scc1 L_cd_57
  s_sleep 1
  s_mov_b64 exec, 0xffff
  buffer_load_dword v254, v235, s[4:7], s43 offen offset:1020 sc1
  s_waitcnt vmcnt(0)
  v_cmp_eq_u32 vcc, -1, v254
  s_mov_b64 exec, -1
  s_cbranch_vccnz L_rt_56
  s_add_u32 s58, s43, 8192
  buffer_load_dwordx4 v[96:99], v1, s[4:7], s58 offen offset:0 sc1
  buffer_load_dwordx4 v[100:103], v1, s[4:7], s58 offen offset:1024 sc1
  buffer_load_dwordx4 v[104:107], v1, s[4:7], s58 offen offset:2048 sc1
  buffer_load_dwordx4 v[108:111], v1, s[4:7], s58 offen offset:3072 sc1
  s_add_u32 s58, s43, 12288
  buffer_load_dwordx4 v[112:115], v1, s[4:7], s58 offen offset:0 sc1
  buffer_load_dwordx4 v[116:119], v1, s[4:7], s58 offen offset:1024 sc1
  buffer_load_dwordx4 v[120:123], v1, s[4:7], s58 offen offset:2048 sc1
  buffer_load_dwordx4 v[124:127], v1, s[4:7], s58 offen offset:3072 sc1
  s_waitcnt vmcnt(0)
  s_branch L_chk_55
  s_nop 15
  s_nop 3
L_rt_59:
  s_add_u32 s90, s90, 1
  s_add_u32 s56, s56, 1
  s_cmp_gt_u32 s56, 0x40000
  s_cbranch_scc1 L_cd_60
  s_sleep 1
  s_mov_b64 exec, 0xffff
  buffer_load_dword v254, v235, s[4:7], s43 offen offset:1020 sc1
  s_waitcnt vmcnt(0)
  v_cmp_eq_u32 vcc, -1, v254
  s_mov_b64 exec, -1
  s_cbranch_vccnz L_rt_59
  s_add_u32 s58, s43, 12288
  buffer_load_dwordx4 v[112:115], v1, s[4:7], s58 offen offset:0 sc1
  buffer_load_dwordx4 v[116:119], v1, s[4:7], s58 offen offset:1024 sc1
  buffer_load_dwordx4 v[120:123], v1, s[4:7], s58 offen offset:2048 sc1
  buffer_load_dwordx4 v[124:127], v1, s[4:7], s58 offen offset:3072 sc1
  s_waitcnt vmcnt(0)
  s_branch L_chk_58
  s_endpgm
L_code_end:
.section .rodata,"a"
.p2align 6
.amdhsa_kernel prep_kernel
  .amdhsa_next_free_vgpr 112
  .amdhsa_next_free_sgpr 102
  .amdhsa_accum_offset 112
  .amdhsa_group_segment_fixed_size 0
  .amdhsa_kernarg_size 80
  .amdhsa_user_sgpr_count 2
  .amdhsa_user_sgpr_kernarg_segment_ptr 1
  .amdhsa_system_sgpr_workgroup_id_x 1
.end_amdhsa_kernel

.p2align 6
.amdhsa_kernel main_kernel
  .amdhsa_next_free_vgpr 256
  .amdhsa_next_free_sgpr 102
  .amdhsa_accum_offset 256
  .amdhsa_group_segment_fixed_size 0
  .amdhsa_kernarg_size 80
  .amdhsa_user_sgpr_count 2
  .amdhsa_user_sgpr_kernarg_segment_ptr 1
  .amdhsa_system_sgpr_workgroup_id_x 1
.end_amdhsa_kernel
```
